```python
import torch

def _softmax(x, axis=-1):
    return torch.softmax(x, dim=axis)
def _gelu(x):
    return torch.nn.functional.gelu(x, approximate="tanh")
def _silu(x):
    return torch.nn.functional.silu(x)
def _sigmoid(x):
    return torch.sigmoid(x)
def _layernorm(x, axis=-1, eps=1e-5):
    m = x.mean(dim=axis, keepdim=True)
    v = x.var(dim=axis, keepdim=True, unbiased=False)
    return (x - m) / torch.sqrt(v + eps)
def _scatter_add(tgt, idx, src, axis=0):
    return tgt.clone().index_add_(axis, idx, src)
def _segment_sum(src, seg, n):
    out = torch.zeros((n,) + src.shape[1:], dtype=src.dtype)
    return out.index_add_(0, seg, src)
def _pad(x, pw):
    flat = tuple(v for pair in reversed(pw) for v in pair)
    return torch.nn.functional.pad(x, flat)

kernel_name = 'sequential_preLN__linear_kernel_hedgehog__mixer_s_mlp__prompt'

def setup_inputs():

    _w = (lambda a: (lambda t: t.to(torch.bfloat16) if t.is_floating_point() else t)(torch.as_tensor(a)))
    def _A_setup():
        B, S, D, H = 1, 2048, 512, 32
        Dh = D // H
        return {
            "x": _w((lambda *s: torch.randn(*s, dtype=torch.bfloat16) * 0.05)(B, S, D)),
            "wqkv": _w((lambda *s: torch.randn(*s, dtype=torch.bfloat16) * 0.2)(D, 3 * D)),
            "w_phi": _w((lambda *s: torch.randn(*s, dtype=torch.bfloat16) * 0.2)(H, Dh, Dh) * (Dh ** -0.5)),
            "wo": _w((lambda *s: torch.randn(*s, dtype=torch.bfloat16) * 0.05)(D, D)),
        }
    _A_in = _A_setup()

    def _B_setup():
        B, S, D, F = 1, 2048, 512, 1376
        return {
            "x":  _w((lambda *s: torch.randn(*s, dtype=torch.bfloat16) * 0.05)(B, S, D)),
            "w1": _w((lambda *s: torch.randn(*s, dtype=torch.bfloat16) * 3.2)(D, D) * (D ** -0.5)),
            "w2": _w((lambda *s: torch.randn(*s, dtype=torch.bfloat16) * 3.2)(D, D) * (D ** -0.5)),
            "w3": _w((lambda *s: torch.randn(*s, dtype=torch.bfloat16) * 3.2)(D, F) * (D ** -0.5)),
            "w4": _w((lambda *s: torch.randn(*s, dtype=torch.bfloat16) * 3.2)(F, D) * (F ** -0.5)),
        }
    _B_in = _B_setup()

    return {
        "A_x": _A_in["x"],
        "A_wqkv": _A_in["wqkv"],
        "A_w_phi": _A_in["w_phi"],
        "A_wo": _A_in["wo"],
        "B_x": _B_in["x"],
        "B_w1": _B_in["w1"],
        "B_w2": _B_in["w2"],
        "B_w3": _B_in["w3"],
        "B_w4": _B_in["w4"],
    }

def reference(A_x, A_wqkv, A_w_phi, A_wo, B_x, B_w1, B_w2, B_w3, B_w4):
    def _A_ref(x, wqkv, w_phi, wo):
        B, S, D = x.shape
        H = 32; Dh = D // H
        qkv = (lambda x, *d: x.permute(*d))((x @ wqkv).reshape(B, S, 3, H, Dh), 2, 0, 3, 1, 4)
        q, k, v = qkv[0], qkv[1], qkv[2]
        pq = torch.einsum("bhsd,hdf->bhsf", q, w_phi)
        pk = torch.einsum("bhsd,hdf->bhsf", k, w_phi)
        phi_q = torch.concatenate([_softmax(pq, axis=-1), _softmax(-pq, axis=-1)], axis=-1)
        phi_k = torch.concatenate([_softmax(pk, axis=-1), _softmax(-pk, axis=-1)], axis=-1)
        kv = torch.einsum("bhsf,bhsd->bhfd", phi_k, v)
        z  = torch.einsum("bhsf->bhf", phi_k)
        num = torch.einsum("bhqf,bhfd->bhqd", phi_q, kv)
        den = torch.einsum("bhqf,bhf->bhq", phi_q, z)[..., None] + 1e-6
        o = num / den
        return (lambda x, *d: x.permute(*d))(o, 0, 2, 1, 3).reshape(B, S, D) @ wo

    def _B_ref(x, w1, w2, w3, w4):
        B, S, D = x.shape
        h = _gelu(_layernorm(x, axis=-1) @ w1)
        c = D // 4
        g0 = _pad(h[:, :, 0*c:1*c], ((0, 0), (1, 0), (0, 0)))[:, :S, :]
        g1 = _pad(h[:, :, 1*c:2*c], ((0, 0), (0, 1), (0, 0)))[:, 1:, :]
        g2 = _pad(h[:, :, 2*c:3*c], ((0, 0), (2, 0), (0, 0)))[:, :S, :]
        g3 = _pad(h[:, :, 3*c:   ], ((0, 0), (0, 2), (0, 0)))[:, 2:, :]
        hs = torch.concatenate([g0, g1, g2, g3], axis=-1) @ w2
        x1 = x + hs
        h2 = _gelu(_layernorm(x1, axis=-1) @ w3) @ w4
        return x1 + h2

    x = A_x
    h = x + _A_ref(_layernorm(x, axis=-1), A_wqkv, A_w_phi, A_wo)
    h2 = h + _B_ref(_layernorm(h, axis=-1), B_w1, B_w2, B_w3, B_w4)
    return h2
```

```asm
; @launch grid=(256,1,1) block=(256,1,1) lds=163840
.amdgcn_target "amdgcn-amd-amdhsa--gfx950"
.text
.globl sequential_preLN__linear_kernel_hedgehog__mixer_s_mlp__prompt_kernel
.p2align 8
.type sequential_preLN__linear_kernel_hedgehog__mixer_s_mlp__prompt_kernel,@function
sequential_preLN__linear_kernel_hedgehog__mixer_s_mlp__prompt_kernel:
s_cmp_ge_u32 s2, 256
s_cbranch_scc1 L_end
s_load_dwordx4 s[8:11], s[0:1], 0
v_lshrrev_b32 v2, 6, v0
v_and_b32 v0, 63, v0
s_and_b32 s48, s2, 7
s_lshr_b32 s62, s2, 3
v_readfirstlane_b32 s52, v2
s_and_b32 s50, s62, 7
s_lshr_b32 s49, s62, 3
s_lshl_b32 s51, s48, 2
s_add_u32 s51, s51, s49
v_lshrrev_b32 v3, 4, v0
v_lshrrev_b32 v10, 3, v0
v_and_b32 v11, 7, v0
v_lshlrev_b32 v13, 10, v10
v_xor_b32_e64 v14, v11, v3
v_mul_u32_u24 v15, 3072, v10
v_and_b32 v16, 2, v10
v_xor_b32 v16, v11, v16
s_lshl_b32 s60, s52, 11
s_lshl_b32 s62, s51, 16
s_lshl_b32 s63, s52, 14
s_add_u32 s62, s62, s63
s_mul_i32 s64, s52, 49152
s_lshl_b32 s63, s50, 7
s_add_u32 s64, s64, s63
v_add_u32 v13, s62, v13
v_add_u32 v15, s64, v15
v_lshl_add_u32 v4, v14, 4, v13
v_lshl_add_u32 v6, v16, 4, v15
v_xor_b32 v14, 4, v14
v_xor_b32 v16, 4, v16
v_lshl_add_u32 v5, v14, 4, v13
v_lshl_add_u32 v7, v16, 4, v15
v_add_u32 v5, 0x1c00, v5
v_add_u32 v7, 23552, v7
s_lshl_b32 s89, s49, 1
s_add_u32 s89, s89, s50
s_waitcnt lgkmcnt(0)
s_mov_b32 s12, s10
s_mov_b32 s13, s11
s_nop 0
s_mov_b32 s10, 0x200000
s_mov_b32 s11, 0x20000
s_mov_b32 s14, 0x180000
s_mov_b32 s15, 0x20000
s_load_dwordx2 s[44:45], s[0:1], 88
s_load_dwordx2 s[16:17], s[0:1], 16
s_load_dwordx2 s[20:21], s[0:1], 24
s_load_dwordx2 s[24:25], s[0:1], 40
s_load_dwordx2 s[28:29], s[0:1], 48
s_load_dwordx2 s[32:33], s[0:1], 56
s_load_dwordx2 s[36:37], s[0:1], 64
s_load_dwordx2 s[40:41], s[0:1], 72
s_add_u32 s0, s89, 0
s_and_b32 s0, s0, 7
s_mul_i32 s1, s0, 196608
s_lshl_b32 s0, s0, 7
s_add_u32 m0, s60, 0
s_nop 0
s_nop 0
buffer_load_dwordx4 v4, s[8:11], s0 offen offset:0 lds
buffer_load_dwordx4 v5, s[8:11], s0 offen offset:1024 lds
s_add_u32 m0, s60, 65536
s_add_u32 s3, s1, 1024
buffer_load_dwordx4 v6, s[12:15], s3 offen offset:0 lds
buffer_load_dwordx4 v7, s[12:15], s3 offen offset:1024 lds
s_add_u32 s0, s89, 1
s_and_b32 s0, s0, 7
s_mul_i32 s1, s0, 196608
s_lshl_b32 s0, s0, 7
s_nop 0
s_add_u32 m0, s60, 73728
s_add_u32 s3, s1, 1024
buffer_load_dwordx4 v6, s[12:15], s3 offen offset:0 lds
buffer_load_dwordx4 v7, s[12:15], s3 offen offset:1024 lds
s_getpc_b64 s[92:93]
L_cpc:
s_lshr_b32 s62, s2, 3
s_lshl_b32 s62, s62, 2
s_add_u32 s62, s62, s52
s_lshl_b32 s62, s62, 9
v_and_b32 v18, 3, v0
v_lshlrev_b32 v18, 7, v18
v_add_u32 v18, s62, v18
s_add_u32 s92, s92, Lpg_0-L_cpc
s_addc_u32 s93, s93, 0
v_min_u32 v18, 36736, v18
global_load_dword a200, v18, s[92:93]
v_and_b32 v2, 15, v0
s_lshr_b32 s53, s52, 1
s_and_b32 s54, s52, 1
v_lshlrev_b32 v1, 4, v0
s_lshl_b32 s59, s51, 2
s_add_u32 s59, s59, s52
s_mov_b32 s57, 0
s_getreg_b32 s58, hwreg(HW_REG_XCC_ID, 0, 4)
s_lshl_b32 s96, s52, 14
s_lshl_b32 s97, s52, 17
s_movk_i32 s4, 0x1000
s_movk_i32 s5, 0x2000
s_movk_i32 s6, 0x3000
s_movk_i32 s7, 0x4000
v_lshrrev_b32 v13, 1, v2
v_xor_b32 v13, v13, v3
v_and_b32 v13, 7, v13
v_lshlrev_b32_e64 v13, 4, v13
v_lshl_add_u32 v13, v2, 7, v13
s_lshl_b32 s62, s53, 12
s_lshl_b32 s63, s54, 11
s_add_u32 s62, s62, s63
v_add_u32 v10, s62, v13
v_xor_b32_e64 v11, 64, v10
v_xor_b32 v248, 0x800, v10
v_xor_b32 v249, 0x800, v11
v_lshrrev_b32 v13, 2, v2
v_and_b32 v14, 2, v13
v_and_b32_e64 v15, 1, v3
v_lshl_or_b32 v14, v15, 2, v14
v_bfe_u32 v15, v2, 1, 1
v_xor_b32 v14, v14, v15
v_lshlrev_b32 v14, 4, v14
v_and_b32_e64 v15, 1, v2
v_lshl_add_u32 v14, v15, 3, v14
v_lshl_add_u32 v15, v3, 3, v13
v_lshl_add_u32 v16, v15, 7, v14
v_lshl_add_u32 v15, v3, 2, v13
v_lshl_add_u32 v17, v15, 7, v14
s_lshl_b32 s62, s54, 6
v_xor_b32 v12, s62, v16
v_xor_b32_e64 v13, 32, v12
v_add_u32 v34, 0x10000, v12
v_add_u32 v35, 0x10000, v13
v_lshrrev_b32_e64 v30, 2, v2
v_lshl_add_u32 v30, v3, 2, v30
v_lshlrev_b32 v30, 5, v30
v_and_b32 v31, 3, v2
v_lshl_add_u32 v30, v31, 3, v30
v_mov_b32 v14, v17
v_xor_b32 v15, 32, v17
v_xor_b32_e64 v16, 64, v17
v_xor_b32 v17, 0x60, v17
v_mov_b32 v20, 0x3f803f80
v_mov_b32 v21, 0x3f803f80
v_mov_b32 v22, 0x3f803f80
v_mov_b32 v23, 0x3f803f80
s_waitcnt lgkmcnt(0)
s_nop 0
s_mov_b32 s46, 0x10000000
s_mov_b32 s47, 0x20000
s_mov_b32 s18, 0x4000
s_mov_b32 s19, 0x20000
s_mov_b32 s22, 0x80000
s_mov_b32 s23, 0x20000
s_mov_b32 s26, 0x80000
s_mov_b32 s27, 0x20000
s_mov_b32 s30, 0x80000
s_mov_b32 s31, 0x20000
s_mov_b32 s34, 0x158000
s_mov_b32 s35, 0x20000
s_mov_b32 s38, 0x158000
s_mov_b32 s39, 0x20000
s_mov_b32 s42, 0x200000
s_mov_b32 s43, 0x20000
s_load_dword s55, s[44:45], 0
v_and_b32_e64 v36, 3, v2
v_cmp_eq_u32 s[68:69], 1, v36
v_cmp_eq_u32 s[70:71], 2, v36
v_cmp_eq_u32 s[72:73], 3, v36
v_lshrrev_b32_e64 v37, 2, v2
v_cmp_eq_u32 s[74:75], v37, v3
v_cmp_eq_u32 s[76:77], 0, v2
v_and_b32 v36, 1, v2
v_lshlrev_b32 v36, 4, v36
v_mov_b32 v37, 0x3f80
v_lshlrev_b32 v37, v36, v37
v_and_b32 v36, 2, v2
v_cmp_eq_u32 vcc, 0, v36
s_nop 1
v_cndmask_b32_e64 v38, 0, v37, vcc
v_cndmask_b32 v39, v37, 0, vcc
v_accvgpr_write_b32 a168, v38
v_accvgpr_write_b32 a169, v39
v_cndmask_b32 v37, 0, v37, s[74:75]
v_mov_b32 v24, 0
v_mov_b32 v25, 0
v_mov_b32 v28, 0
v_mov_b32 v29, 0
v_cndmask_b32_e64 v26, 0, v37, vcc
v_cndmask_b32 v27, v37, 0, vcc
v_lshrrev_b32 v18, 3, v0
v_and_b32 v36, 6, v18
v_and_b32 v8, 7, v0
v_xor_b32 v8, v8, v36
v_lshlrev_b32_e64 v8, 4, v8
v_lshl_add_u32 v8, v18, 10, v8
s_lshl_b32 s62, s50, 7
v_add_u32 v8, s62, v8
v_and_b32 v38, 7, v0
v_lshlrev_b32 v38, 2, v38
v_lshlrev_b32 v39, 4, v3
s_lshl_b32 s62, s50, 2
s_lshl_b32 s63, s54, 1
s_add_u32 s62, s62, s63
s_lshl_b32 s63, s49, 1
s_add_u32 s63, s63, s53
s_mul_i32 s64, s48, 720896
s_add_u32 s64, s64, 6291456
s_lshl_b32 s65, s62, 13
s_add_u32 s65, s65, s64
s_lshl_b32 s66, s63, 10
s_add_u32 s65, s65, s66
v_add_u32_e64 v36, s65, v1
v_accvgpr_write_b32 a128, v36
s_lshl_b32 s66, s48, 5
s_add_u32 s62, s62, s66
s_lshl_b32 s65, s62, 10
s_lshl_b32 s67, s63, 7
s_add_u32 s65, s65, s67
s_add_u32 s65, s65, 393216
v_add_u32 v36, s65, v39
v_accvgpr_write_b32 a129, v36
s_lshl_b32 s65, s62, 5
s_lshl_b32 s63, s63, 2
s_add_u32 s65, s65, s63
s_add_u32 s65, s65, 16384
v_mov_b32 v36, s65
v_accvgpr_write_b32 a130, v36
s_lshl_b32 s62, s59, 14
s_lshl_b32 s63, s50, 11
s_add_u32 s62, s62, s63
v_and_b32 v36, 15, v0
v_lshlrev_b32_e64 v36, 7, v36
s_add_u32 s63, s62, 2097152
v_add_u32_e64 v37, s63, v36
s_add_u32 s63, s62, 4194304
v_add_u32 v38, s63, v36
v_cmp_lt_u32 vcc, 15, v0
s_nop 1
v_cndmask_b32 v37, v37, v38, vcc
v_accvgpr_read_b32 v38, a128
v_and_b32 v39, 7, v0
v_lshlrev_b32 v39, 7, v39
v_readfirstlane_b32 s63, v38
v_bfe_u32 v38, v0, 3, 1
v_lshlrev_b32 v38, 13, v38
v_add_u32 v39, v39, v38
v_add_u32 v39, s63, v39
v_cmp_lt_u32 vcc, 31, v0
s_nop 1
v_cndmask_b32_e64 v37, v37, v39, vcc
v_accvgpr_read_b32 v38, a129
v_and_b32 v39, 1, v0
v_readfirstlane_b32 s63, v38
v_lshlrev_b32 v39, 10, v39
s_nop 0
v_add_u32 v39, s63, v39
s_lshl_b32 s64, s59, 12
s_lshl_b32 s65, s50, 7
s_add_u32 s64, s64, s65
s_add_u32 s64, s64, 1048576
v_and_b32 v38, 1, v0
v_lshlrev_b32 v38, 11, v38
v_add_u32 v38, s64, v38
v_cmp_lt_u32 vcc, 55, v0
s_nop 1
v_cndmask_b32 v39, v39, v38, vcc
v_cmp_lt_u32 vcc, 47, v0
s_nop 1
v_cndmask_b32_e64 v37, v37, v39, vcc
v_accvgpr_write_b32 a161, v37
s_mul_i32 s63, s59, 45056
s_mul_i32 s64, s50, 192
s_mul_i32 s65, s50, 160
s_add_u32 s65, s65, 96
s_cmp_lt_u32 s50, 3
s_cselect_b32 s87, s64, s65
s_cselect_b32 s88, 8, 4
s_mul_i32 s64, s50, 6144
s_add_u32 s63, s63, s64
s_add_u32 s63, s63, 6291456
v_min_u32 v38, 47, v0
v_lshlrev_b32 v38, 7, v38
v_add_u32_e64 v38, s63, v38
v_accvgpr_write_b32 a162, v38
s_lshl_b32 s62, s59, 14
s_lshl_b32 s63, s50, 7
s_add_u32 s62, s62, s63
v_lshlrev_b32 v36, 3, v36
v_add_u32_e64 v36, s62, v36
v_accvgpr_write_b32 a163, v36
s_lshr_b32 s62, s2, 3
s_lshl_b32 s62, s62, 2
s_add_u32 s62, s62, s52
s_lshl_b32 s63, s62, 5
v_and_b32 v36, 31, v0
v_add_u32 v36, s63, v36
v_lshlrev_b32_e64 v37, 7, v36
v_accvgpr_write_b32 a164, v37
v_lshrrev_b32_e64 v37, 3, v36
v_mul_u32_u24 v37, 3072, v37
v_and_b32_e64 v36, 7, v36
v_lshl_add_u32 v37, v36, 7, v37
v_accvgpr_write_b32 a165, v37
s_mul_i32 s63, s62, 96
v_add_u32 v36, s63, v0
v_lshlrev_b32 v36, 7, v36
v_accvgpr_write_b32 a166, v36
v_and_b32 v37, 31, v0
v_add_u32 v37, s63, v37
v_lshlrev_b32_e64 v37, 7, v37
v_add_u32 v37, 0x2000, v37
v_accvgpr_write_b32 a167, v37
s_add_u32 s0, s89, 1
s_and_b32 s0, s0, 7
s_mul_i32 s1, s0, 196608
s_lshl_b32 s0, s0, 7
s_add_u32 m0, s60, 8192
s_nop 0
buffer_load_dwordx4 v4, s[8:11], s0 offen offset:0 lds
buffer_load_dwordx4 v5, s[8:11], s0 offen offset:1024 lds
s_add_u32 s0, s89, 2
s_and_b32 s0, s0, 7
s_mul_i32 s1, s0, 196608
s_lshl_b32 s0, s0, 7
s_add_u32 m0, s60, 16384
s_nop 0
buffer_load_dwordx4 v4, s[8:11], s0 offen offset:0 lds
buffer_load_dwordx4 v5, s[8:11], s0 offen offset:1024 lds
s_add_u32 m0, s60, 81920
s_add_u32 s3, s1, 1024
buffer_load_dwordx4 v6, s[12:15], s3 offen offset:0 lds
buffer_load_dwordx4 v7, s[12:15], s3 offen offset:1024 lds
s_add_u32 s0, s89, 3
s_and_b32 s0, s0, 7
s_mul_i32 s1, s0, 196608
s_lshl_b32 s0, s0, 7
s_add_u32 m0, s60, 24576
s_nop 0
buffer_load_dwordx4 v4, s[8:11], s0 offen offset:0 lds
buffer_load_dwordx4 v5, s[8:11], s0 offen offset:1024 lds
s_add_u32 m0, s60, 90112
s_add_u32 s3, s1, 1024
buffer_load_dwordx4 v6, s[12:15], s3 offen offset:0 lds
buffer_load_dwordx4 v7, s[12:15], s3 offen offset:1024 lds
s_waitcnt lgkmcnt(0)
s_add_u32 s55, s55, 0x9e3779b0
v_mov_b32 v9, s55
s_add_u32 s62, s55, s58
v_mov_b32 v18, s62
s_lshl_b32 s63, s48, 7
s_lshl_b32 s64, s49, 5
s_add_u32 s63, s63, s64
s_lshl_b32 s64, s50, 2
s_add_u32 s63, s63, s64
s_add_u32 s63, s63, 4096
s_cmp_lg_u32 s52, 0
s_cselect_b32 s63, 0x40000000, s63
v_mov_b32 v36, s63
v_mov_b32 v37, 0x40000000
v_cmp_eq_u32 vcc, 0, v0
s_nop 1
v_cndmask_b32 v36, v37, v36, vcc
buffer_store_dword v18, v36, s[44:47], 0 offen sc1
s_mov_b32 s78, 0x3fb8aa3b
s_mov_b32 s79, 0xbfb8aa3b
s_mov_b32 s80, 0xc0135761
s_mov_b32 s81, 0xbdd2d3e8
s_mov_b32 s82, 0x3727c5ac
s_mov_b32 s83, 0x3b000000
s_mov_b32 s94, 1.0
s_mov_b32 s95, 1.0
s_branch Lpg_0_n
.p2align 12
Lpg_0:
s_setpc_b64 s[100:101]
s_nop 0
Lpg_0_n:
s_waitcnt vmcnt(14)
s_barrier
ds_read_b128 a[0:3], v10 offset:0
ds_read_b128 a[64:67], v248 offset:0
ds_read_b64_tr_b16 v[128:129], v34 offset:0
ds_read_b64_tr_b16 v[130:131], v34 offset:512
ds_read_b64_tr_b16 v[132:133], v35 offset:0
ds_read_b64_tr_b16 v[134:135], v35 offset:512
ds_read_b128 a[4:7], v11 offset:0
ds_read_b128 a[68:71], v249 offset:0
ds_read_b64_tr_b16 v[136:137], v34 offset:4096
ds_read_b64_tr_b16 v[138:139], v34 offset:4608
ds_read_b64_tr_b16 v[140:141], v35 offset:4096
ds_read_b64_tr_b16 v[142:143], v35 offset:4608
s_waitcnt vmcnt(5)
s_barrier
s_waitcnt lgkmcnt(0)
v_mfma_f32_16x16x32_bf16 v[40:43], v[128:131], a[0:3], 0
s_add_u32 s0, s89, 4
v_mfma_f32_16x16x32_bf16 v[44:47], v[128:131], a[64:67], 0
s_and_b32 s0, s0, 7
ds_read_b128 a[8:11], v10 offset:8192
v_mfma_f32_16x16x32_bf16 v[56:59], v[128:131], v[20:23], 0
s_mul_i32 s1, s0, 196608
ds_read_b128 a[72:75], v248 offset:8192
v_mfma_f32_16x16x32_bf16 v[48:51], v[132:135], a[0:3], 0
s_lshl_b32 s0, s0, 7
v_mfma_f32_16x16x32_bf16 v[52:55], v[132:135], a[64:67], 0
s_add_u32 m0, s60, 32768
ds_read_b64_tr_b16 v[144:145], v34 offset:8192
v_mfma_f32_16x16x32_bf16 v[60:63], v[132:135], v[20:23], 0
buffer_load_dwordx4 v4, s[8:11], s0 offen offset:0 lds
ds_read_b64_tr_b16 v[146:147], v34 offset:8704
v_mfma_f32_16x16x32_bf16 v[64:67], v[20:23], a[0:3], 0
buffer_load_dwordx4 v5, s[8:11], s0 offen offset:1024 lds
v_mfma_f32_16x16x32_bf16 v[72:75], a[0:3], a[0:3], 0
s_add_u32 m0, s60, 98304
ds_read_b64_tr_b16 v[148:149], v35 offset:8192
v_mfma_f32_16x16x32_bf16 v[40:43], v[136:139], a[4:7], v[40:43]
s_add_u32 s3, s1, 1024
ds_read_b64_tr_b16 v[150:151], v35 offset:8704
v_mfma_f32_16x16x32_bf16 v[44:47], v[136:139], a[68:71], v[44:47]
buffer_load_dwordx4 v6, s[12:15], s3 offen offset:0 lds
v_mfma_f32_16x16x32_bf16 v[56:59], v[136:139], v[20:23], v[56:59]
buffer_load_dwordx4 v7, s[12:15], s3 offen offset:1024 lds
ds_read_b128 a[12:15], v11 offset:8192
v_mfma_f32_16x16x32_bf16 v[48:51], v[140:143], a[4:7], v[48:51]
ds_read_b128 a[76:79], v249 offset:8192
v_mfma_f32_16x16x32_bf16 v[52:55], v[140:143], a[68:71], v[52:55]
ds_read_b64_tr_b16 v[152:153], v34 offset:12288
v_mfma_f32_16x16x32_bf16 v[60:63], v[140:143], v[20:23], v[60:63]
v_mfma_f32_16x16x32_bf16 v[64:67], v[20:23], a[4:7], v[64:67]
ds_read_b64_tr_b16 v[154:155], v34 offset:12800
v_mfma_f32_16x16x32_bf16 v[72:75], a[4:7], a[4:7], v[72:75]
ds_read_b64_tr_b16 v[156:157], v35 offset:12288
ds_read_b64_tr_b16 v[158:159], v35 offset:12800
s_waitcnt lgkmcnt(0)
v_mfma_f32_16x16x32_bf16 v[40:43], v[144:147], a[8:11], v[40:43]
s_add_u32 s0, s89, 5
v_mfma_f32_16x16x32_bf16 v[44:47], v[144:147], a[72:75], v[44:47]
s_and_b32 s0, s0, 7
ds_read_b128 a[16:19], v10 offset:16384
v_mfma_f32_16x16x32_bf16 v[56:59], v[144:147], v[20:23], v[56:59]
s_mul_i32 s1, s0, 196608
ds_read_b128 a[80:83], v248 offset:16384
v_mfma_f32_16x16x32_bf16 v[48:51], v[148:151], a[8:11], v[48:51]
s_lshl_b32 s0, s0, 7
v_mfma_f32_16x16x32_bf16 v[52:55], v[148:151], a[72:75], v[52:55]
s_add_u32 m0, s60, 40960
ds_read_b64_tr_b16 v[128:129], v34 offset:16384
v_mfma_f32_16x16x32_bf16 v[60:63], v[148:151], v[20:23], v[60:63]
buffer_load_dwordx4 v4, s[8:11], s0 offen offset:0 lds
ds_read_b64_tr_b16 v[130:131], v34 offset:16896
v_mfma_f32_16x16x32_bf16 v[64:67], v[20:23], a[8:11], v[64:67]
buffer_load_dwordx4 v5, s[8:11], s0 offen offset:1024 lds
v_mfma_f32_16x16x32_bf16 v[72:75], a[8:11], a[8:11], v[72:75]
s_add_u32 m0, s60, 106496
ds_read_b64_tr_b16 v[132:133], v35 offset:16384
v_mfma_f32_16x16x32_bf16 v[40:43], v[152:155], a[12:15], v[40:43]
s_add_u32 s3, s1, 1024
ds_read_b64_tr_b16 v[134:135], v35 offset:16896
v_mfma_f32_16x16x32_bf16 v[44:47], v[152:155], a[76:79], v[44:47]
buffer_load_dwordx4 v6, s[12:15], s3 offen offset:0 lds
v_mfma_f32_16x16x32_bf16 v[56:59], v[152:155], v[20:23], v[56:59]
buffer_load_dwordx4 v7, s[12:15], s3 offen offset:1024 lds
ds_read_b128 a[20:23], v11 offset:16384
v_mfma_f32_16x16x32_bf16 v[48:51], v[156:159], a[12:15], v[48:51]
ds_read_b128 a[84:87], v249 offset:16384
v_mfma_f32_16x16x32_bf16 v[52:55], v[156:159], a[76:79], v[52:55]
ds_read_b64_tr_b16 v[136:137], v34 offset:20480
v_mfma_f32_16x16x32_bf16 v[60:63], v[156:159], v[20:23], v[60:63]
v_mfma_f32_16x16x32_bf16 v[64:67], v[20:23], a[12:15], v[64:67]
ds_read_b64_tr_b16 v[138:139], v34 offset:20992
v_mfma_f32_16x16x32_bf16 v[72:75], a[12:15], a[12:15], v[72:75]
ds_read_b64_tr_b16 v[140:141], v35 offset:20480
ds_read_b64_tr_b16 v[142:143], v35 offset:20992
s_waitcnt vmcnt(4)
s_barrier
s_waitcnt lgkmcnt(0)
v_mfma_f32_16x16x32_bf16 v[40:43], v[128:131], a[16:19], v[40:43]
s_add_u32 s0, s89, 6
v_mfma_f32_16x16x32_bf16 v[44:47], v[128:131], a[80:83], v[44:47]
s_and_b32 s0, s0, 7
ds_read_b128 a[24:27], v10 offset:24576
v_mfma_f32_16x16x32_bf16 v[56:59], v[128:131], v[20:23], v[56:59]
s_mul_i32 s1, s0, 196608
ds_read_b128 a[88:91], v248 offset:24576
v_mfma_f32_16x16x32_bf16 v[48:51], v[132:135], a[16:19], v[48:51]
s_lshl_b32 s0, s0, 7
v_mfma_f32_16x16x32_bf16 v[52:55], v[132:135], a[80:83], v[52:55]
s_add_u32 m0, s60, 49152
ds_read_b64_tr_b16 v[144:145], v34 offset:24576
v_mfma_f32_16x16x32_bf16 v[60:63], v[132:135], v[20:23], v[60:63]
buffer_load_dwordx4 v4, s[8:11], s0 offen offset:0 lds
ds_read_b64_tr_b16 v[146:147], v34 offset:25088
v_mfma_f32_16x16x32_bf16 v[64:67], v[20:23], a[16:19], v[64:67]
buffer_load_dwordx4 v5, s[8:11], s0 offen offset:1024 lds
v_mfma_f32_16x16x32_bf16 v[72:75], a[16:19], a[16:19], v[72:75]
s_add_u32 m0, s60, 114688
ds_read_b64_tr_b16 v[148:149], v35 offset:24576
v_mfma_f32_16x16x32_bf16 v[40:43], v[136:139], a[20:23], v[40:43]
s_add_u32 s3, s1, 1024
ds_read_b64_tr_b16 v[150:151], v35 offset:25088
v_mfma_f32_16x16x32_bf16 v[44:47], v[136:139], a[84:87], v[44:47]
buffer_load_dwordx4 v6, s[12:15], s3 offen offset:0 lds
v_mfma_f32_16x16x32_bf16 v[56:59], v[136:139], v[20:23], v[56:59]
buffer_load_dwordx4 v7, s[12:15], s3 offen offset:1024 lds
ds_read_b128 a[28:31], v11 offset:24576
v_mfma_f32_16x16x32_bf16 v[48:51], v[140:143], a[20:23], v[48:51]
ds_read_b128 a[92:95], v249 offset:24576
v_mfma_f32_16x16x32_bf16 v[52:55], v[140:143], a[84:87], v[52:55]
ds_read_b64_tr_b16 v[152:153], v34 offset:28672
v_mfma_f32_16x16x32_bf16 v[60:63], v[140:143], v[20:23], v[60:63]
v_mfma_f32_16x16x32_bf16 v[64:67], v[20:23], a[20:23], v[64:67]
ds_read_b64_tr_b16 v[154:155], v34 offset:29184
v_mfma_f32_16x16x32_bf16 v[72:75], a[20:23], a[20:23], v[72:75]
ds_read_b64_tr_b16 v[156:157], v35 offset:28672
ds_read_b64_tr_b16 v[158:159], v35 offset:29184
s_waitcnt lgkmcnt(0)
v_mfma_f32_16x16x32_bf16 v[40:43], v[144:147], a[24:27], v[40:43]
s_lshl_b32 s92, s48, 7
v_mfma_f32_16x16x32_bf16 v[44:47], v[144:147], a[88:91], v[44:47]
s_add_u32 s92, s92, 4096
ds_read_b128 a[32:35], v10 offset:32768
v_mfma_f32_16x16x32_bf16 v[56:59], v[144:147], v[20:23], v[56:59]
v_and_b32_e64 v250, 31, v0
ds_read_b128 a[96:99], v248 offset:32768
v_mfma_f32_16x16x32_bf16 v[48:51], v[148:151], a[24:27], v[48:51]
v_lshlrev_b32_e64 v250, 2, v250
v_mfma_f32_16x16x32_bf16 v[52:55], v[148:151], a[88:91], v[52:55]
v_add_u32_e64 v250, s92, v250
ds_read_b64_tr_b16 v[128:129], v34 offset:32768
v_mfma_f32_16x16x32_bf16 v[60:63], v[148:151], v[20:23], v[60:63]
buffer_load_dword v251, v250, s[44:47], 0 offen sc1
ds_read_b64_tr_b16 v[130:131], v34 offset:33280
v_mfma_f32_16x16x32_bf16 v[64:67], v[20:23], a[24:27], v[64:67]
s_add_u32 s0, s89, 7
v_mfma_f32_16x16x32_bf16 v[72:75], a[24:27], a[24:27], v[72:75]
s_and_b32 s0, s0, 7
ds_read_b64_tr_b16 v[132:133], v35 offset:32768
v_mfma_f32_16x16x32_bf16 v[40:43], v[152:155], a[28:31], v[40:43]
s_mul_i32 s1, s0, 196608
ds_read_b64_tr_b16 v[134:135], v35 offset:33280
v_mfma_f32_16x16x32_bf16 v[44:47], v[152:155], a[92:95], v[44:47]
s_lshl_b32 s0, s0, 7
v_mfma_f32_16x16x32_bf16 v[56:59], v[152:155], v[20:23], v[56:59]
s_add_u32 m0, s60, 57344
ds_read_b128 a[36:39], v11 offset:32768
v_mfma_f32_16x16x32_bf16 v[48:51], v[156:159], a[28:31], v[48:51]
buffer_load_dwordx4 v4, s[8:11], s0 offen offset:0 lds
ds_read_b128 a[100:103], v249 offset:32768
v_mfma_f32_16x16x32_bf16 v[52:55], v[156:159], a[92:95], v[52:55]
buffer_load_dwordx4 v5, s[8:11], s0 offen offset:1024 lds
ds_read_b64_tr_b16 v[136:137], v34 offset:36864
v_mfma_f32_16x16x32_bf16 v[60:63], v[156:159], v[20:23], v[60:63]
s_add_u32 m0, s60, 122880
v_mfma_f32_16x16x32_bf16 v[64:67], v[20:23], a[28:31], v[64:67]
s_add_u32 s3, s1, 1024
ds_read_b64_tr_b16 v[138:139], v34 offset:37376
v_mfma_f32_16x16x32_bf16 v[72:75], a[28:31], a[28:31], v[72:75]
s_nop 0
buffer_load_dwordx4 v6, s[12:15], s3 offen offset:0 lds
ds_read_b64_tr_b16 v[140:141], v35 offset:36864
buffer_load_dwordx4 v7, s[12:15], s3 offen offset:1024 lds
ds_read_b64_tr_b16 v[142:143], v35 offset:37376
s_waitcnt vmcnt(5)
s_barrier
s_waitcnt lgkmcnt(0)
v_mfma_f32_16x16x32_bf16 v[40:43], v[128:131], a[32:35], v[40:43]
s_add_u32 s0, s89, 0
v_mfma_f32_16x16x32_bf16 v[44:47], v[128:131], a[96:99], v[44:47]
s_and_b32 s0, s0, 7
ds_read_b128 a[40:43], v10 offset:40960
v_mfma_f32_16x16x32_bf16 v[56:59], v[128:131], v[20:23], v[56:59]
s_mul_i32 s1, s0, 196608
ds_read_b128 a[104:107], v248 offset:40960
v_mfma_f32_16x16x32_bf16 v[48:51], v[132:135], a[32:35], v[48:51]
s_lshl_b32 s0, s0, 7
v_mfma_f32_16x16x32_bf16 v[52:55], v[132:135], a[96:99], v[52:55]
s_add_u32 m0, s60, 131072
ds_read_b64_tr_b16 v[144:145], v34 offset:40960
v_mfma_f32_16x16x32_bf16 v[60:63], v[132:135], v[20:23], v[60:63]
s_add_u32 s3, s1, 2048
ds_read_b64_tr_b16 v[146:147], v34 offset:41472
v_mfma_f32_16x16x32_bf16 v[64:67], v[20:23], a[32:35], v[64:67]
buffer_load_dwordx4 v6, s[12:15], s3 offen offset:0 lds
v_mfma_f32_16x16x32_bf16 v[72:75], a[32:35], a[32:35], v[72:75]
buffer_load_dwordx4 v7, s[12:15], s3 offen offset:1024 lds
ds_read_b64_tr_b16 v[148:149], v35 offset:40960
v_mfma_f32_16x16x32_bf16 v[40:43], v[136:139], a[36:39], v[40:43]
s_add_u32 s0, s89, 1
ds_read_b64_tr_b16 v[150:151], v35 offset:41472
v_mfma_f32_16x16x32_bf16 v[44:47], v[136:139], a[100:103], v[44:47]
s_and_b32 s0, s0, 7
v_mfma_f32_16x16x32_bf16 v[56:59], v[136:139], v[20:23], v[56:59]
s_mul_i32 s1, s0, 196608
ds_read_b128 a[44:47], v11 offset:40960
v_mfma_f32_16x16x32_bf16 v[48:51], v[140:143], a[36:39], v[48:51]
s_lshl_b32 s0, s0, 7
ds_read_b128 a[108:111], v249 offset:40960
v_mfma_f32_16x16x32_bf16 v[52:55], v[140:143], a[100:103], v[52:55]
s_add_u32 m0, s60, 139264
ds_read_b64_tr_b16 v[152:153], v34 offset:45056
v_mfma_f32_16x16x32_bf16 v[60:63], v[140:143], v[20:23], v[60:63]
s_add_u32 s3, s1, 2048
v_mfma_f32_16x16x32_bf16 v[64:67], v[20:23], a[36:39], v[64:67]
buffer_load_dwordx4 v6, s[12:15], s3 offen offset:0 lds
ds_read_b64_tr_b16 v[154:155], v34 offset:45568
v_mfma_f32_16x16x32_bf16 v[72:75], a[36:39], a[36:39], v[72:75]
s_nop 0
buffer_load_dwordx4 v7, s[12:15], s3 offen offset:1024 lds
ds_read_b64_tr_b16 v[156:157], v35 offset:45056
ds_read_b64_tr_b16 v[158:159], v35 offset:45568
s_waitcnt lgkmcnt(0)
v_mfma_f32_16x16x32_bf16 v[40:43], v[144:147], a[40:43], v[40:43]
s_add_u32 s0, s89, 2
v_mfma_f32_16x16x32_bf16 v[44:47], v[144:147], a[104:107], v[44:47]
s_and_b32 s0, s0, 7
ds_read_b128 a[48:51], v10 offset:49152
v_mfma_f32_16x16x32_bf16 v[56:59], v[144:147], v[20:23], v[56:59]
s_mul_i32 s1, s0, 196608
ds_read_b128 a[112:115], v248 offset:49152
v_mfma_f32_16x16x32_bf16 v[48:51], v[148:151], a[40:43], v[48:51]
s_lshl_b32 s0, s0, 7
v_mfma_f32_16x16x32_bf16 v[52:55], v[148:151], a[104:107], v[52:55]
s_add_u32 m0, s60, 147456
ds_read_b64_tr_b16 v[128:129], v34 offset:49152
v_mfma_f32_16x16x32_bf16 v[60:63], v[148:151], v[20:23], v[60:63]
s_add_u32 s3, s1, 2048
ds_read_b64_tr_b16 v[130:131], v34 offset:49664
v_mfma_f32_16x16x32_bf16 v[64:67], v[20:23], a[40:43], v[64:67]
buffer_load_dwordx4 v6, s[12:15], s3 offen offset:0 lds
v_mfma_f32_16x16x32_bf16 v[72:75], a[40:43], a[40:43], v[72:75]
buffer_load_dwordx4 v7, s[12:15], s3 offen offset:1024 lds
ds_read_b64_tr_b16 v[132:133], v35 offset:49152
v_mfma_f32_16x16x32_bf16 v[40:43], v[152:155], a[44:47], v[40:43]
s_add_u32 s0, s89, 3
ds_read_b64_tr_b16 v[134:135], v35 offset:49664
v_mfma_f32_16x16x32_bf16 v[44:47], v[152:155], a[108:111], v[44:47]
s_and_b32 s0, s0, 7
v_mfma_f32_16x16x32_bf16 v[56:59], v[152:155], v[20:23], v[56:59]
s_mul_i32 s1, s0, 196608
ds_read_b128 a[52:55], v11 offset:49152
v_mfma_f32_16x16x32_bf16 v[48:51], v[156:159], a[44:47], v[48:51]
s_lshl_b32 s0, s0, 7
ds_read_b128 a[116:119], v249 offset:49152
v_mfma_f32_16x16x32_bf16 v[52:55], v[156:159], a[108:111], v[52:55]
s_add_u32 m0, s60, 155648
ds_read_b64_tr_b16 v[136:137], v34 offset:53248
v_mfma_f32_16x16x32_bf16 v[60:63], v[156:159], v[20:23], v[60:63]
s_add_u32 s3, s1, 2048
v_mfma_f32_16x16x32_bf16 v[64:67], v[20:23], a[44:47], v[64:67]
buffer_load_dwordx4 v6, s[12:15], s3 offen offset:0 lds
ds_read_b64_tr_b16 v[138:139], v34 offset:53760
v_mfma_f32_16x16x32_bf16 v[72:75], a[44:47], a[44:47], v[72:75]
s_nop 0
buffer_load_dwordx4 v7, s[12:15], s3 offen offset:1024 lds
ds_read_b64_tr_b16 v[140:141], v35 offset:53248
ds_read_b64_tr_b16 v[142:143], v35 offset:53760
s_waitcnt vmcnt(8)
s_barrier
s_waitcnt lgkmcnt(0)
v_mfma_f32_16x16x32_bf16 v[40:43], v[128:131], a[48:51], v[40:43]
s_add_u32 s0, s89, 4
v_mfma_f32_16x16x32_bf16 v[44:47], v[128:131], a[112:115], v[44:47]
s_and_b32 s0, s0, 7
ds_read_b128 a[56:59], v10 offset:57344
v_mfma_f32_16x16x32_bf16 v[56:59], v[128:131], v[20:23], v[56:59]
s_mul_i32 s1, s0, 196608
ds_read_b128 a[120:123], v248 offset:57344
v_mfma_f32_16x16x32_bf16 v[48:51], v[132:135], a[48:51], v[48:51]
s_lshl_b32 s0, s0, 7
v_mfma_f32_16x16x32_bf16 v[52:55], v[132:135], a[112:115], v[52:55]
s_add_u32 m0, s60, 0
ds_read_b64_tr_b16 v[144:145], v34 offset:57344
v_mfma_f32_16x16x32_bf16 v[60:63], v[132:135], v[20:23], v[60:63]
s_add_u32 s3, s1, 2048
ds_read_b64_tr_b16 v[146:147], v34 offset:57856
v_mfma_f32_16x16x32_bf16 v[64:67], v[20:23], a[48:51], v[64:67]
buffer_load_dwordx4 v6, s[12:15], s3 offen offset:0 lds
v_mfma_f32_16x16x32_bf16 v[72:75], a[48:51], a[48:51], v[72:75]
buffer_load_dwordx4 v7, s[12:15], s3 offen offset:1024 lds
ds_read_b64_tr_b16 v[148:149], v35 offset:57344
v_mfma_f32_16x16x32_bf16 v[40:43], v[136:139], a[52:55], v[40:43]
s_add_u32 s0, s89, 5
ds_read_b64_tr_b16 v[150:151], v35 offset:57856
v_mfma_f32_16x16x32_bf16 v[44:47], v[136:139], a[116:119], v[44:47]
s_and_b32 s0, s0, 7
v_mfma_f32_16x16x32_bf16 v[56:59], v[136:139], v[20:23], v[56:59]
s_mul_i32 s1, s0, 196608
ds_read_b128 a[60:63], v11 offset:57344
v_mfma_f32_16x16x32_bf16 v[48:51], v[140:143], a[52:55], v[48:51]
s_lshl_b32 s0, s0, 7
ds_read_b128 a[124:127], v249 offset:57344
v_mfma_f32_16x16x32_bf16 v[52:55], v[140:143], a[116:119], v[52:55]
s_add_u32 m0, s60, 8192
ds_read_b64_tr_b16 v[152:153], v34 offset:61440
v_mfma_f32_16x16x32_bf16 v[60:63], v[140:143], v[20:23], v[60:63]
s_add_u32 s3, s1, 2048
v_mfma_f32_16x16x32_bf16 v[64:67], v[20:23], a[52:55], v[64:67]
buffer_load_dwordx4 v6, s[12:15], s3 offen offset:0 lds
ds_read_b64_tr_b16 v[154:155], v34 offset:61952
v_mfma_f32_16x16x32_bf16 v[72:75], a[52:55], a[52:55], v[72:75]
buffer_load_dwordx4 v7, s[12:15], s3 offen offset:1024 lds
ds_read_b64_tr_b16 v[156:157], v35 offset:61440
ds_read_b64_tr_b16 v[158:159], v35 offset:61952
s_waitcnt lgkmcnt(0)
v_mfma_f32_16x16x32_bf16 v[40:43], v[144:147], a[56:59], v[40:43]
s_lshl_b32 s62, s50, 2
v_mfma_f32_16x16x32_bf16 v[44:47], v[144:147], a[120:123], v[44:47]
s_lshl_b32 s63, s54, 1
s_add_u32 s62, s62, s63
v_mfma_f32_16x16x32_bf16 v[56:59], v[144:147], v[20:23], v[56:59]
s_lshl_b32 s62, s62, 9
v_mfma_f32_16x16x32_bf16 v[48:51], v[148:151], a[56:59], v[48:51]
s_lshl_b32 s63, s52, 10
s_add_u32 m0, s63, 40960
v_mfma_f32_16x16x32_bf16 v[52:55], v[148:151], a[120:123], v[52:55]
buffer_load_dwordx4 v1, s[16:19], s62 offen offset:0 lds
v_mfma_f32_16x16x32_bf16 v[60:63], v[148:151], v[20:23], v[60:63]
v_add_u32_e64 v30, s63, v30
v_mfma_f32_16x16x32_bf16 v[64:67], v[20:23], a[56:59], v[64:67]
v_mfma_f32_16x16x32_bf16 v[72:75], a[56:59], a[56:59], v[72:75]
v_mfma_f32_16x16x32_bf16 v[40:43], v[152:155], a[60:63], v[40:43]
v_mfma_f32_16x16x32_bf16 v[44:47], v[152:155], a[124:127], v[44:47]
v_mfma_f32_16x16x32_bf16 v[56:59], v[152:155], v[20:23], v[56:59]
v_mfma_f32_16x16x32_bf16 v[48:51], v[156:159], a[60:63], v[48:51]
v_mfma_f32_16x16x32_bf16 v[52:55], v[156:159], a[124:127], v[52:55]
v_mfma_f32_16x16x32_bf16 v[60:63], v[156:159], v[20:23], v[60:63]
v_mfma_f32_16x16x32_bf16 v[64:67], v[20:23], a[60:63], v[64:67]
v_mfma_f32_16x16x32_bf16 v[72:75], a[60:63], a[60:63], v[72:75]
s_mov_b32 s61, 0x8000
Lid_1:
v_subrev_u32 v252, s55, v251
v_cmp_lt_u32 vcc, 7, v252
s_cbranch_vccz Lidd_2
buffer_load_dword v251, v250, s[44:47], 0 offen sc1
s_waitcnt vmcnt(0)
s_sub_u32 s61, s61, 1
s_cmp_lg_u32 s61, 0
s_cbranch_scc1 Lid_1
s_mov_b32 s57, 1
Lidd_2:
v_cmp_ne_u32 vcc, s58, v252
s_nop 0
s_cmp_eq_u64 vcc, 0
s_cselect_b32 s56, 1, 0
v_add_u32 v34, 0x20000, v12
v_add_u32 v35, 0x20000, v13
s_waitcnt vmcnt(9)
s_barrier
ds_read_b64_tr_b16 v[128:129], v34 offset:0
ds_read_b64_tr_b16 v[130:131], v34 offset:512
ds_read_b64_tr_b16 v[132:133], v35 offset:0
ds_read_b64_tr_b16 v[134:135], v35 offset:512
ds_read_b64_tr_b16 v[136:137], v34 offset:4096
ds_read_b64_tr_b16 v[138:139], v34 offset:4608
ds_read_b64_tr_b16 v[140:141], v35 offset:4096
ds_read_b64_tr_b16 v[142:143], v35 offset:4608
s_waitcnt lgkmcnt(0)
v_mfma_f32_16x16x32_bf16 v[80:83], a[0:3], v[128:131], 0
s_add_u32 s0, s89, 6
v_cndmask_b32 v160, v72, v73, s[68:69]
v_cndmask_b32 v160, v160, v74, s[70:71]
v_mfma_f32_16x16x32_bf16 v[88:91], a[64:67], v[128:131], 0
ds_read_b64_tr_b16 v[144:145], v34 offset:8192
s_and_b32 s0, s0, 7
v_cndmask_b32 v160, v160, v75, s[72:73]
v_cndmask_b32 v160, 0, v160, s[74:75]
v_mul_f32 v36, s83, v64
v_mfma_f32_16x16x32_bf16 v[96:99], v[20:23], v[128:131], 0
ds_read_b64_tr_b16 v[146:147], v34 offset:8704
s_mul_i32 s1, s0, 196608
v_mov_b32 v161, v160
s_nop 1
v_permlane32_swap_b32 v160, v161
v_add_f32 v160, v160, v161
v_mfma_f32_16x16x32_bf16 v[84:87], a[0:3], v[132:135], 0
s_lshl_b32 s0, s0, 7
v_mov_b32 v161, v160
s_nop 1
v_permlane16_swap_b32 v160, v161
v_add_f32_e64 v160, v160, v161
v_mfma_f32_16x16x32_bf16 v[92:95], a[64:67], v[132:135], 0
ds_read_b64_tr_b16 v[148:149], v35 offset:8192
s_add_u32 m0, s60, 16384
v_mov_b32 v161, v160
s_nop 1
v_permlane32_swap_b32 v160, v161
v_mfma_f32_16x16x32_bf16 v[100:103], v[20:23], v[132:135], 0
ds_read_b64_tr_b16 v[150:151], v35 offset:8704
s_add_u32 s3, s1, 2048
v_mul_f32 v160, s83, v160
v_fma_f32 v160, -v36, v36, v160
v_max_f32_e64 v160, 0, v160
v_mfma_f32_16x16x32_bf16 v[80:83], a[4:7], v[136:139], v[80:83]
buffer_load_dwordx4 v6, s[12:15], s3 offen offset:0 lds
v_add_f32 v160, s82, v160
v_rsq_f32 v38, v160
s_lshl_b32 s62, s53, 7
v_mfma_f32_16x16x32_bf16 v[88:91], a[68:71], v[136:139], v[88:91]
ds_read_b64_tr_b16 v[152:153], v34 offset:12288
buffer_load_dwordx4 v7, s[12:15], s3 offen offset:1024 lds
s_lshl_b32 s63, s54, 6
s_add_u32 s62, s62, s63
v_lshlrev_b32 v253, 2, v2
v_mfma_f32_16x16x32_bf16 v[96:99], v[20:23], v[136:139], v[96:99]
ds_read_b64_tr_b16 v[154:155], v34 offset:12800
s_add_u32 s0, s89, 7
v_add_u32 v253, s62, v253
v_lshlrev_b32_e64 v254, 4, v3
v_mfma_f32_16x16x32_bf16 v[84:87], a[4:7], v[140:143], v[84:87]
s_and_b32 s0, s0, 7
v_add_u32 v254, s62, v254
v_xor_b32 v251, 64, v253
v_xor_b32 v252, 64, v254
v_mfma_f32_16x16x32_bf16 v[92:95], a[68:71], v[140:143], v[92:95]
ds_read_b64_tr_b16 v[156:157], v35 offset:12288
s_mul_i32 s1, s0, 196608
ds_write_b32 v253, v36 offset:32768
ds_write_b32 v253, v38 offset:33024
s_waitcnt vmcnt(2)
ds_read_b64_tr_b16 v[32:33], v30 offset:41472
v_mfma_f32_16x16x32_bf16 v[100:103], v[20:23], v[140:143], v[100:103]
ds_read_b64_tr_b16 v[158:159], v35 offset:12800
s_lshl_b32 s0, s0, 7
ds_read_b64_tr_b16 v[30:31], v30 offset:40960
s_waitcnt lgkmcnt(0)
s_nop 0
s_add_u32 m0, s60, 24576
s_add_u32 s3, s1, 2048
buffer_load_dwordx4 v6, s[12:15], s3 offen offset:0 lds
buffer_load_dwordx4 v7, s[12:15], s3 offen offset:1024 lds
v_accvgpr_read_b32 v236, a161
buffer_load_dword a200, v236, s[44:47], 0 offen
s_barrier
v_mfma_f32_16x16x32_bf16 v[80:83], a[8:11], v[144:147], v[80:83]
ds_read_b32 v37, v251 offset:32768
ds_read_b32 v39, v251 offset:33024
s_waitcnt lgkmcnt(0)
v_mov_b32_e64 v240, v36
v_mfma_f32_16x16x32_bf16 v[88:91], a[72:75], v[144:147], v[88:91]
ds_read_b64_tr_b16 v[128:129], v34 offset:16384
v_mov_b32 v241, v36
v_mov_b32 v242, v37
v_mov_b32_e64 v243, v37
v_mfma_f32_16x16x32_bf16 v[96:99], v[20:23], v[144:147], v[96:99]
ds_read_b64_tr_b16 v[130:131], v34 offset:16896
v_mov_b32 v244, v38
v_mov_b32 v245, v38
v_mov_b32_e64 v246, v39
v_mfma_f32_16x16x32_bf16 v[84:87], a[8:11], v[148:151], v[84:87]
v_mov_b32_e64 v247, v39
v_pk_fma_f32 v[160:161], v[56:57], v[240:241], v[40:41] neg_lo:[1,0,0] neg_hi:[1,0,0]
v_pk_fma_f32 v[162:163], v[58:59], v[240:241], v[42:43] neg_lo:[1,0,0] neg_hi:[1,0,0]
v_mfma_f32_16x16x32_bf16 v[92:95], a[72:75], v[148:151], v[92:95]
ds_read_b64_tr_b16 v[132:133], v35 offset:16384
v_pk_fma_f32 v[176:177], v[56:57], v[242:243], v[44:45] neg_lo:[1,0,0] neg_hi:[1,0,0]
v_pk_fma_f32 v[178:179], v[58:59], v[242:243], v[46:47] neg_lo:[1,0,0] neg_hi:[1,0,0]
v_pk_fma_f32 v[192:193], v[60:61], v[240:241], v[48:49] neg_lo:[1,0,0] neg_hi:[1,0,0]
v_mfma_f32_16x16x32_bf16 v[100:103], v[20:23], v[148:151], v[100:103]
ds_read_b64_tr_b16 v[134:135], v35 offset:16896
v_pk_fma_f32 v[194:195], v[62:63], v[240:241], v[50:51] neg_lo:[1,0,0] neg_hi:[1,0,0]
v_pk_fma_f32 v[208:209], v[60:61], v[242:243], v[52:53] neg_lo:[1,0,0] neg_hi:[1,0,0]
v_pk_fma_f32 v[210:211], v[62:63], v[242:243], v[54:55] neg_lo:[1,0,0] neg_hi:[1,0,0]
v_mfma_f32_16x16x32_bf16 v[80:83], a[12:15], v[152:155], v[80:83]
v_pk_mul_f32 v[160:161], v[160:161], v[244:245]
v_pk_mul_f32 v[162:163], v[162:163], v[244:245]
v_pk_mul_f32 v[176:177], v[176:177], v[246:247]
v_pk_mul_f32 v[178:179], v[178:179], v[246:247]
v_mfma_f32_16x16x32_bf16 v[88:91], a[76:79], v[152:155], v[88:91]
ds_read_b64_tr_b16 v[136:137], v34 offset:20480
v_pk_mul_f32 v[192:193], v[192:193], v[244:245]
v_pk_mul_f32 v[194:195], v[194:195], v[244:245]
v_pk_mul_f32 v[208:209], v[208:209], v[246:247]
v_mfma_f32_16x16x32_bf16 v[96:99], v[20:23], v[152:155], v[96:99]
ds_read_b64_tr_b16 v[138:139], v34 offset:20992
v_pk_mul_f32 v[210:211], v[210:211], v[246:247]
v_cvt_pk_bf16_f32 v164, v160, v161
v_cvt_pk_bf16_f32 v165, v162, v163
v_mfma_f32_16x16x32_bf16 v[84:87], a[12:15], v[156:159], v[84:87]
v_cvt_pk_bf16_f32 v180, v176, v177
v_cvt_pk_bf16_f32 v181, v178, v179
v_cvt_pk_bf16_f32 v196, v192, v193
v_mfma_f32_16x16x32_bf16 v[92:95], a[76:79], v[156:159], v[92:95]
ds_read_b64_tr_b16 v[140:141], v35 offset:20480
v_cvt_pk_bf16_f32 v197, v194, v195
v_cvt_pk_bf16_f32 v212, v208, v209
v_cvt_pk_bf16_f32 v213, v210, v211
v_mfma_f32_16x16x32_bf16 v[100:103], v[20:23], v[156:159], v[100:103]
ds_read_b64_tr_b16 v[142:143], v35 offset:20992
v_mfma_f32_16x16x16_bf16 v[160:163], v[30:31], v[164:165], 0
v_mfma_f32_16x16x16_bf16 v[176:179], v[30:31], v[180:181], 0
v_mfma_f32_16x16x16_bf16 v[192:195], v[32:33], v[196:197], 0
s_waitcnt lgkmcnt(0)
v_mfma_f32_16x16x32_bf16 v[80:83], a[16:19], v[128:131], v[80:83]
v_mfma_f32_16x16x16_bf16 v[208:211], v[32:33], v[212:213], 0
s_nop 2
v_max3_f32 v164, v160, v161, v162
v_max3_f32 v165, -v160, -v161, -v162
v_mfma_f32_16x16x32_bf16 v[88:91], a[80:83], v[128:131], v[88:91]
ds_read_b64_tr_b16 v[144:145], v34 offset:24576
v_max3_f32 v180, v176, v177, v178
v_max3_f32 v181, -v176, -v177, -v178
v_max3_f32 v196, v192, v193, v194
v_mfma_f32_16x16x32_bf16 v[96:99], v[20:23], v[128:131], v[96:99]
ds_read_b64_tr_b16 v[146:147], v34 offset:25088
v_max3_f32 v197, -v192, -v193, -v194
v_max3_f32 v212, v208, v209, v210
v_max3_f32 v213, -v208, -v209, -v210
v_mfma_f32_16x16x32_bf16 v[84:87], a[16:19], v[132:135], v[84:87]
v_max_f32_e64 v164, v164, v163
v_max_f32_e64 v165, v165, -v163
v_max_f32_e64 v180, v180, v179
v_mfma_f32_16x16x32_bf16 v[92:95], a[80:83], v[132:135], v[92:95]
ds_read_b64_tr_b16 v[148:149], v35 offset:24576
v_max_f32_e64 v181, v181, -v179
v_max_f32_e64 v196, v196, v195
v_max_f32_e64 v197, v197, -v195
v_mfma_f32_16x16x32_bf16 v[100:103], v[20:23], v[132:135], v[100:103]
ds_read_b64_tr_b16 v[150:151], v35 offset:25088
v_max_f32_e64 v212, v212, v211
v_max_f32_e64 v213, v213, -v211
v_permlane32_swap_b32 v164, v165
v_mfma_f32_16x16x32_bf16 v[80:83], a[20:23], v[136:139], v[80:83]
v_permlane32_swap_b32 v180, v181
v_permlane32_swap_b32 v196, v197
v_permlane32_swap_b32 v212, v213
v_max_f32_e64 v164, v164, v165
v_mfma_f32_16x16x32_bf16 v[88:91], a[84:87], v[136:139], v[88:91]
ds_read_b64_tr_b16 v[152:153], v34 offset:28672
v_max_f32 v180, v180, v181
v_max_f32 v196, v196, v197
v_max_f32_e64 v212, v212, v213
v_mfma_f32_16x16x32_bf16 v[96:99], v[20:23], v[136:139], v[96:99]
ds_read_b64_tr_b16 v[154:155], v34 offset:29184
v_mov_b32 v165, v164
v_mov_b32 v181, v180
v_mov_b32_e64 v197, v196
v_mfma_f32_16x16x32_bf16 v[84:87], a[20:23], v[140:143], v[84:87]
v_mov_b32 v213, v212
v_permlane16_swap_b32 v164, v165
v_permlane16_swap_b32 v180, v181
v_mfma_f32_16x16x32_bf16 v[92:95], a[84:87], v[140:143], v[92:95]
ds_read_b64_tr_b16 v[156:157], v35 offset:28672
v_permlane16_swap_b32 v196, v197
v_permlane16_swap_b32 v212, v213
v_max_f32 v164, v164, v165
v_mfma_f32_16x16x32_bf16 v[100:103], v[20:23], v[140:143], v[100:103]
ds_read_b64_tr_b16 v[158:159], v35 offset:29184
v_max_f32 v180, v180, v181
v_max_f32 v196, v196, v197
v_max_f32 v212, v212, v213
v_mov_b32 v165, v164
s_barrier
s_waitcnt lgkmcnt(0)
v_mov_b32 v34, v12
v_mov_b32 v35, v13
s_branch Lpg_1_n
.p2align 12
Lpg_1:
s_setpc_b64 s[100:101]
s_nop 0
Lpg_1_n:
v_mfma_f32_16x16x32_bf16 v[80:83], a[24:27], v[144:147], v[80:83]
v_mov_b32 v181, v180
v_mov_b32 v197, v196
v_mov_b32_e64 v213, v212
v_mfma_f32_16x16x32_bf16 v[88:91], a[88:91], v[144:147], v[88:91]
ds_read_b64_tr_b16 v[128:129], v34 offset:0
v_permlane32_swap_b32 v164, v165
v_permlane32_swap_b32 v180, v181
v_permlane32_swap_b32 v196, v197
v_mfma_f32_16x16x32_bf16 v[96:99], v[20:23], v[144:147], v[96:99]
ds_read_b64_tr_b16 v[130:131], v34 offset:512
v_permlane32_swap_b32 v212, v213
v_mul_f32 v164, s78, v164
v_mul_f32 v165, s78, v165
v_mfma_f32_16x16x32_bf16 v[84:87], a[24:27], v[148:151], v[84:87]
v_mul_f32 v180, s78, v180
v_mul_f32 v181, s78, v181
v_mul_f32_e64 v196, s78, v196
v_mfma_f32_16x16x32_bf16 v[92:95], a[88:91], v[148:151], v[92:95]
ds_read_b64_tr_b16 v[132:133], v35 offset:0
v_mul_f32 v197, s78, v197
v_mul_f32 v212, s78, v212
v_mul_f32_e64 v213, s78, v213
v_mfma_f32_16x16x32_bf16 v[100:103], v[20:23], v[148:151], v[100:103]
ds_read_b64_tr_b16 v[134:135], v35 offset:512
v_fma_f32 v168, v160, s78, -v164
v_fma_f32 v169, v160, s79, -v165
v_fma_f32 v184, v176, s78, -v180
v_mfma_f32_16x16x32_bf16 v[80:83], a[28:31], v[152:155], v[80:83]
v_fma_f32 v185, v176, s79, -v181
v_fma_f32 v200, v192, s78, -v196
v_fma_f32 v201, v192, s79, -v197
v_fma_f32 v216, v208, s78, -v212
v_mfma_f32_16x16x32_bf16 v[88:91], a[92:95], v[152:155], v[88:91]
ds_read_b64_tr_b16 v[136:137], v34 offset:4096
v_fma_f32 v217, v208, s79, -v213
v_fma_f32 v170, v161, s78, -v164
v_fma_f32 v171, v161, s79, -v165
v_mfma_f32_16x16x32_bf16 v[96:99], v[20:23], v[152:155], v[96:99]
ds_read_b64_tr_b16 v[138:139], v34 offset:4608
v_fma_f32 v186, v177, s78, -v180
v_fma_f32 v187, v177, s79, -v181
v_fma_f32 v202, v193, s78, -v196
v_mfma_f32_16x16x32_bf16 v[84:87], a[28:31], v[156:159], v[84:87]
v_fma_f32 v203, v193, s79, -v197
v_fma_f32 v218, v209, s78, -v212
v_fma_f32 v219, v209, s79, -v213
v_mfma_f32_16x16x32_bf16 v[92:95], a[92:95], v[156:159], v[92:95]
ds_read_b64_tr_b16 v[140:141], v35 offset:4096
v_fma_f32 v172, v162, s78, -v164
v_fma_f32 v173, v162, s79, -v165
v_fma_f32 v188, v178, s78, -v180
v_mfma_f32_16x16x32_bf16 v[100:103], v[20:23], v[156:159], v[100:103]
ds_read_b64_tr_b16 v[142:143], v35 offset:4608
v_fma_f32 v189, v178, s79, -v181
v_fma_f32 v204, v194, s78, -v196
v_fma_f32 v205, v194, s79, -v197
v_fma_f32 v220, v210, s78, -v212
s_waitcnt lgkmcnt(0)
v_mfma_f32_16x16x32_bf16 v[80:83], a[32:35], v[128:131], v[80:83]
s_add_u32 s0, s89, 0
v_fma_f32 v221, v210, s79, -v213
v_fma_f32 v174, v163, s78, -v164
v_fma_f32 v175, v163, s79, -v165
v_mfma_f32_16x16x32_bf16 v[88:91], a[96:99], v[128:131], v[88:91]
ds_read_b64_tr_b16 v[144:145], v34 offset:8192
s_and_b32 s0, s0, 7
s_nop 0
v_fma_f32 v190, v179, s78, -v180
v_fma_f32 v191, v179, s79, -v181
v_fma_f32 v206, v195, s78, -v196
v_mfma_f32_16x16x32_bf16 v[96:99], v[20:23], v[128:131], v[96:99]
ds_read_b64_tr_b16 v[146:147], v34 offset:8704
s_mul_i32 s1, s0, 196608
v_fma_f32 v207, v195, s79, -v197
v_fma_f32 v222, v211, s78, -v212
v_fma_f32 v223, v211, s79, -v213
v_mfma_f32_16x16x32_bf16 v[84:87], a[32:35], v[132:135], v[84:87]
s_lshl_b32 s0, s0, 7
v_exp_f32 v168, v168
v_exp_f32 v184, v184
v_exp_f32 v200, v200
v_mfma_f32_16x16x32_bf16 v[92:95], a[96:99], v[132:135], v[92:95]
ds_read_b64_tr_b16 v[148:149], v35 offset:8192
s_add_u32 m0, s60, 65536
v_exp_f32 v216, v216
v_exp_f32 v169, v169
v_exp_f32_e64 v185, v185
v_mfma_f32_16x16x32_bf16 v[100:103], v[20:23], v[132:135], v[100:103]
ds_read_b64_tr_b16 v[150:151], v35 offset:8704
buffer_load_dwordx4 v6, s[12:15], s1 offen offset:0 lds
v_exp_f32 v201, v201
v_exp_f32 v217, v217
v_exp_f32_e64 v170, v170
v_mfma_f32_16x16x32_bf16 v[80:83], a[36:39], v[136:139], v[80:83]
buffer_load_dwordx4 v7, s[12:15], s1 offen offset:1024 lds
v_exp_f32 v186, v186
v_exp_f32 v202, v202
v_exp_f32 v218, v218
v_exp_f32 v171, v171
v_mfma_f32_16x16x32_bf16 v[88:91], a[100:103], v[136:139], v[88:91]
ds_read_b64_tr_b16 v[152:153], v34 offset:12288
s_add_u32 s0, s89, 1
v_exp_f32 v187, v187
v_exp_f32 v203, v203
v_exp_f32 v219, v219
v_mfma_f32_16x16x32_bf16 v[96:99], v[20:23], v[136:139], v[96:99]
ds_read_b64_tr_b16 v[154:155], v34 offset:12800
s_and_b32 s0, s0, 7
v_exp_f32 v172, v172
v_exp_f32 v188, v188
v_exp_f32 v204, v204
v_mfma_f32_16x16x32_bf16 v[84:87], a[36:39], v[140:143], v[84:87]
s_mul_i32 s1, s0, 196608
v_exp_f32 v220, v220
v_exp_f32 v173, v173
v_exp_f32_e64 v189, v189
v_mfma_f32_16x16x32_bf16 v[92:95], a[100:103], v[140:143], v[92:95]
ds_read_b64_tr_b16 v[156:157], v35 offset:12288
s_lshl_b32 s0, s0, 7
v_exp_f32 v205, v205
v_exp_f32 v221, v221
v_exp_f32 v174, v174
v_mfma_f32_16x16x32_bf16 v[100:103], v[20:23], v[140:143], v[100:103]
ds_read_b64_tr_b16 v[158:159], v35 offset:12800
s_add_u32 m0, s60, 73728
v_exp_f32 v190, v190
v_exp_f32 v206, v206
v_exp_f32_e64 v222, v222
buffer_load_dwordx4 v6, s[12:15], s1 offen offset:0 lds
buffer_load_dwordx4 v7, s[12:15], s1 offen offset:1024 lds
v_exp_f32 v175, v175
s_waitcnt vmcnt(5)
s_barrier
s_waitcnt lgkmcnt(0)
v_mfma_f32_16x16x32_bf16 v[80:83], a[40:43], v[144:147], v[80:83]
s_add_u32 s0, s89, 2
v_exp_f32 v191, v191
v_exp_f32 v207, v207
v_exp_f32 v223, v223
v_mfma_f32_16x16x32_bf16 v[88:91], a[104:107], v[144:147], v[88:91]
ds_read_b64_tr_b16 v[128:129], v34 offset:16384
s_and_b32 s0, s0, 7
s_nop 0
v_pk_add_f32 v[160:161], v[168:169], v[170:171]
v_pk_add_f32 v[162:163], v[172:173], v[174:175]
v_pk_add_f32 v[176:177], v[184:185], v[186:187]
v_mfma_f32_16x16x32_bf16 v[96:99], v[20:23], v[144:147], v[96:99]
ds_read_b64_tr_b16 v[130:131], v34 offset:16896
s_mul_i32 s1, s0, 196608
v_pk_add_f32 v[178:179], v[188:189], v[190:191]
v_pk_add_f32 v[192:193], v[200:201], v[202:203]
v_pk_add_f32 v[194:195], v[204:205], v[206:207]
v_mfma_f32_16x16x32_bf16 v[84:87], a[40:43], v[148:151], v[84:87]
s_lshl_b32 s0, s0, 7
s_nop 0
v_pk_add_f32 v[208:209], v[216:217], v[218:219]
v_pk_add_f32 v[210:211], v[220:221], v[222:223]
v_pk_add_f32 v[160:161], v[160:161], v[162:163]
v_mfma_f32_16x16x32_bf16 v[92:95], a[104:107], v[148:151], v[92:95]
ds_read_b64_tr_b16 v[132:133], v35 offset:16384
s_add_u32 m0, s60, 81920
v_pk_add_f32 v[176:177], v[176:177], v[178:179]
v_pk_add_f32 v[192:193], v[192:193], v[194:195]
v_pk_add_f32 v[208:209], v[208:209], v[210:211]
v_mfma_f32_16x16x32_bf16 v[100:103], v[20:23], v[148:151], v[100:103]
ds_read_b64_tr_b16 v[134:135], v35 offset:16896
buffer_load_dwordx4 v6, s[12:15], s1 offen offset:0 lds
v_permlane32_swap_b32 v160, v161
v_permlane32_swap_b32 v176, v177
v_permlane32_swap_b32 v192, v193
v_mfma_f32_16x16x32_bf16 v[80:83], a[44:47], v[152:155], v[80:83]
buffer_load_dwordx4 v7, s[12:15], s1 offen offset:1024 lds
v_permlane32_swap_b32 v208, v209
v_add_f32 v160, v160, v161
v_add_f32 v176, v176, v177
v_add_f32_e64 v192, v192, v193
v_mfma_f32_16x16x32_bf16 v[88:91], a[108:111], v[152:155], v[88:91]
ds_read_b64_tr_b16 v[136:137], v34 offset:20480
s_add_u32 s0, s89, 3
v_add_f32 v208, v208, v209
v_mov_b32 v161, v160
v_mov_b32 v177, v176
v_mfma_f32_16x16x32_bf16 v[96:99], v[20:23], v[152:155], v[96:99]
ds_read_b64_tr_b16 v[138:139], v34 offset:20992
s_and_b32 s0, s0, 7
v_mov_b32 v193, v192
v_mov_b32 v209, v208
v_permlane16_swap_b32 v160, v161
v_mfma_f32_16x16x32_bf16 v[84:87], a[44:47], v[156:159], v[84:87]
s_mul_i32 s1, s0, 196608
v_permlane16_swap_b32 v176, v177
v_permlane16_swap_b32 v192, v193
v_permlane16_swap_b32 v208, v209
v_mfma_f32_16x16x32_bf16 v[92:95], a[108:111], v[156:159], v[92:95]
ds_read_b64_tr_b16 v[140:141], v35 offset:20480
s_lshl_b32 s0, s0, 7
v_add_f32 v160, v160, v161
v_add_f32 v176, v176, v177
v_add_f32_e64 v192, v192, v193
v_mfma_f32_16x16x32_bf16 v[100:103], v[20:23], v[156:159], v[100:103]
ds_read_b64_tr_b16 v[142:143], v35 offset:20992
s_add_u32 m0, s60, 90112
v_add_f32 v208, v208, v209
v_mov_b32 v161, v160
v_mov_b32_e64 v177, v176
buffer_load_dwordx4 v6, s[12:15], s1 offen offset:0 lds
buffer_load_dwordx4 v7, s[12:15], s1 offen offset:1024 lds
v_mov_b32 v193, v192
s_waitcnt lgkmcnt(0)
v_mfma_f32_16x16x32_bf16 v[80:83], a[48:51], v[128:131], v[80:83]
s_add_u32 s0, s89, 4
v_mov_b32 v209, v208
v_permlane32_swap_b32 v160, v161
v_permlane32_swap_b32 v176, v177
v_mfma_f32_16x16x32_bf16 v[88:91], a[112:115], v[128:131], v[88:91]
ds_read_b64_tr_b16 v[144:145], v34 offset:24576
s_and_b32 s0, s0, 7
v_permlane32_swap_b32 v192, v193
v_permlane32_swap_b32 v208, v209
v_rcp_f32 v160, v160
v_mfma_f32_16x16x32_bf16 v[96:99], v[20:23], v[128:131], v[96:99]
ds_read_b64_tr_b16 v[146:147], v34 offset:25088
s_mul_i32 s1, s0, 196608
v_rcp_f32 v161, v161
v_rcp_f32 v176, v176
v_rcp_f32_e64 v177, v177
v_mfma_f32_16x16x32_bf16 v[84:87], a[48:51], v[132:135], v[84:87]
s_lshl_b32 s0, s0, 7
v_rcp_f32 v192, v192
v_rcp_f32 v193, v193
v_rcp_f32 v208, v208
v_mfma_f32_16x16x32_bf16 v[92:95], a[112:115], v[132:135], v[92:95]
ds_read_b64_tr_b16 v[148:149], v35 offset:24576
s_add_u32 m0, s60, 98304
v_rcp_f32_e64 v209, v209
v_pk_mul_f32 v[168:169], v[168:169], v[160:161]
v_pk_mul_f32 v[184:185], v[184:185], v[176:177]
v_mfma_f32_16x16x32_bf16 v[100:103], v[20:23], v[132:135], v[100:103]
ds_read_b64_tr_b16 v[150:151], v35 offset:25088
buffer_load_dwordx4 v6, s[12:15], s1 offen offset:0 lds
v_pk_mul_f32 v[200:201], v[200:201], v[192:193]
v_pk_mul_f32 v[216:217], v[216:217], v[208:209]
v_pk_mul_f32 v[170:171], v[170:171], v[160:161]
v_mfma_f32_16x16x32_bf16 v[80:83], a[52:55], v[136:139], v[80:83]
buffer_load_dwordx4 v7, s[12:15], s1 offen offset:1024 lds
v_pk_mul_f32 v[186:187], v[186:187], v[176:177]
v_pk_mul_f32 v[202:203], v[202:203], v[192:193]
v_pk_mul_f32 v[218:219], v[218:219], v[208:209]
v_pk_mul_f32 v[172:173], v[172:173], v[160:161]
v_mfma_f32_16x16x32_bf16 v[88:91], a[116:119], v[136:139], v[88:91]
ds_read_b64_tr_b16 v[152:153], v34 offset:28672
s_add_u32 s0, s89, 5
s_nop 0
v_pk_mul_f32 v[188:189], v[188:189], v[176:177]
v_pk_mul_f32 v[204:205], v[204:205], v[192:193]
v_pk_mul_f32 v[220:221], v[220:221], v[208:209]
v_mfma_f32_16x16x32_bf16 v[96:99], v[20:23], v[136:139], v[96:99]
ds_read_b64_tr_b16 v[154:155], v34 offset:29184
s_and_b32 s0, s0, 7
s_nop 0
v_pk_mul_f32 v[174:175], v[174:175], v[160:161]
v_pk_mul_f32 v[190:191], v[190:191], v[176:177]
v_pk_mul_f32 v[206:207], v[206:207], v[192:193]
v_mfma_f32_16x16x32_bf16 v[84:87], a[52:55], v[140:143], v[84:87]
s_mul_i32 s1, s0, 196608
v_pk_mul_f32 v[222:223], v[222:223], v[208:209]
v_cvt_pk_bf16_f32 v224, v168, v170
v_cvt_pk_bf16_f32 v225, v172, v174
v_mfma_f32_16x16x32_bf16 v[92:95], a[116:119], v[140:143], v[92:95]
ds_read_b64_tr_b16 v[156:157], v35 offset:28672
s_lshl_b32 s0, s0, 7
s_nop 0
v_cvt_pk_bf16_f32 v226, v169, v171
v_cvt_pk_bf16_f32 v227, v173, v175
v_cvt_pk_bf16_f32 v228, v184, v186
v_mfma_f32_16x16x32_bf16 v[100:103], v[20:23], v[140:143], v[100:103]
ds_read_b64_tr_b16 v[158:159], v35 offset:29184
s_add_u32 m0, s60, 106496
v_cvt_pk_bf16_f32 v229, v188, v190
v_cvt_pk_bf16_f32 v230, v185, v187
v_cvt_pk_bf16_f32 v231, v189, v191
buffer_load_dwordx4 v6, s[12:15], s1 offen offset:0 lds
buffer_load_dwordx4 v7, s[12:15], s1 offen offset:1024 lds
v_cvt_pk_bf16_f32 v232, v200, v202
s_waitcnt lgkmcnt(0)
v_mfma_f32_16x16x32_bf16 v[80:83], a[56:59], v[144:147], v[80:83]
s_add_u32 s0, s89, 6
v_cvt_pk_bf16_f32 v233, v204, v206
v_cvt_pk_bf16_f32 v234, v201, v203
v_mfma_f32_16x16x32_bf16 v[88:91], a[120:123], v[144:147], v[88:91]
s_and_b32 s0, s0, 7
s_nop 0
v_cvt_pk_bf16_f32 v235, v205, v207
v_cvt_pk_bf16_f32 v236, v216, v218
v_cvt_pk_bf16_f32 v237, v220, v222
v_mfma_f32_16x16x32_bf16 v[96:99], v[20:23], v[144:147], v[96:99]
s_mul_i32 s1, s0, 196608
v_cvt_pk_bf16_f32 v238, v217, v219
v_cvt_pk_bf16_f32 v239, v221, v223
v_mfma_f32_16x16x16_bf16 v[160:163], v[224:225], v[26:27], 0
v_mfma_f32_16x16x32_bf16 v[84:87], a[56:59], v[148:151], v[84:87]
s_lshl_b32 s0, s0, 7
v_mfma_f32_16x16x16_bf16 v[164:167], v[226:227], v[26:27], 0
v_mfma_f32_16x16x16_bf16 v[168:171], v[228:229], v[26:27], 0
v_mfma_f32_16x16x16_bf16 v[172:175], v[230:231], v[26:27], 0
v_mfma_f32_16x16x32_bf16 v[92:95], a[120:123], v[148:151], v[92:95]
s_add_u32 m0, s60, 114688
v_mfma_f32_16x16x16_bf16 v[176:179], v[232:233], v[26:27], 0
v_mfma_f32_16x16x16_bf16 v[180:183], v[234:235], v[26:27], 0
v_mfma_f32_16x16x16_bf16 v[184:187], v[236:237], v[26:27], 0
v_mfma_f32_16x16x32_bf16 v[100:103], v[20:23], v[148:151], v[100:103]
buffer_load_dwordx4 v6, s[12:15], s1 offen offset:0 lds
v_mfma_f32_16x16x16_bf16 v[188:191], v[238:239], v[26:27], 0
v_cvt_pk_bf16_f32 v192, v160, v161
v_cvt_pk_bf16_f32 v193, v162, v163
v_mfma_f32_16x16x32_bf16 v[80:83], a[60:63], v[152:155], v[80:83]
s_nop 0
buffer_load_dwordx4 v7, s[12:15], s1 offen offset:1024 lds
v_cvt_pk_bf16_f32 v196, v164, v165
v_cvt_pk_bf16_f32 v197, v166, v167
v_mfma_f32_16x16x32_bf16 v[88:91], a[124:127], v[152:155], v[88:91]
s_add_u32 s0, s89, 7
s_nop 0
v_cvt_pk_bf16_f32 v194, v168, v169
v_cvt_pk_bf16_f32 v195, v170, v171
v_cvt_pk_bf16_f32 v198, v172, v173
v_mfma_f32_16x16x32_bf16 v[96:99], v[20:23], v[152:155], v[96:99]
s_and_b32 s0, s0, 7
s_nop 0
v_cvt_pk_bf16_f32 v199, v174, v175
v_cvt_pk_bf16_f32 v200, v176, v177
v_cvt_pk_bf16_f32 v201, v178, v179
v_mfma_f32_16x16x32_bf16 v[84:87], a[60:63], v[156:159], v[84:87]
s_mul_i32 s1, s0, 196608
v_cvt_pk_bf16_f32 v204, v180, v181
v_cvt_pk_bf16_f32 v205, v182, v183
v_cvt_pk_bf16_f32 v202, v184, v185
v_mfma_f32_16x16x32_bf16 v[92:95], a[124:127], v[156:159], v[92:95]
s_lshl_b32 s0, s0, 7
s_nop 0
v_cvt_pk_bf16_f32 v203, v186, v187
v_cvt_pk_bf16_f32 v206, v188, v189
v_cvt_pk_bf16_f32 v207, v190, v191
v_mfma_f32_16x16x32_bf16 v[100:103], v[20:23], v[156:159], v[100:103]
s_add_u32 m0, s60, 122880
v_accvgpr_read_b32 v248, a128
v_accvgpr_read_b32 v249, a129
v_accvgpr_read_b32 v250, a130
buffer_load_dwordx4 v6, s[12:15], s1 offen offset:0 lds
buffer_load_dwordx4 v7, s[12:15], s1 offen offset:1024 lds
ds_read_b128 v[128:131], v254 offset:32768
ds_read_b128 v[132:135], v254 offset:33024
ds_read_b128 v[136:139], v252 offset:32768
ds_read_b128 v[140:143], v252 offset:33024
s_waitcnt lgkmcnt(0)
s_nop 0
v_pk_fma_f32 v[160:161], v[128:129], v[96:97], v[80:81] neg_lo:[1,0,0] neg_hi:[1,0,0]
v_pk_fma_f32 v[162:163], v[130:131], v[96:97], v[82:83] neg_lo:[1,0,0] neg_hi:[1,0,0]
v_pk_fma_f32 v[164:165], v[128:129], v[100:101], v[84:85] neg_lo:[1,0,0] neg_hi:[1,0,0]
v_pk_fma_f32 v[166:167], v[130:131], v[100:101], v[86:87] neg_lo:[1,0,0] neg_hi:[1,0,0]
v_pk_fma_f32 v[168:169], v[136:137], v[96:97], v[88:89] neg_lo:[1,0,0] neg_hi:[1,0,0]
v_pk_fma_f32 v[170:171], v[138:139], v[96:97], v[90:91] neg_lo:[1,0,0] neg_hi:[1,0,0]
v_pk_fma_f32 v[172:173], v[136:137], v[100:101], v[92:93] neg_lo:[1,0,0] neg_hi:[1,0,0]
v_pk_fma_f32 v[174:175], v[138:139], v[100:101], v[94:95] neg_lo:[1,0,0] neg_hi:[1,0,0]
v_pk_mul_f32 v[160:161], v[160:161], v[132:133]
v_pk_mul_f32 v[162:163], v[162:163], v[134:135]
v_pk_mul_f32 v[164:165], v[164:165], v[132:133]
v_pk_mul_f32 v[166:167], v[166:167], v[134:135]
v_pk_mul_f32 v[168:169], v[168:169], v[140:141]
v_pk_mul_f32 v[170:171], v[170:171], v[142:143]
v_pk_mul_f32 v[172:173], v[172:173], v[140:141]
v_pk_mul_f32 v[174:175], v[174:175], v[142:143]
v_cvt_pk_bf16_f32 v208, v160, v161
v_cvt_pk_bf16_f32 v209, v162, v163
v_cvt_pk_bf16_f32 v212, v164, v165
v_cvt_pk_bf16_f32 v213, v166, v167
v_cvt_pk_bf16_f32 v210, v168, v169
v_cvt_pk_bf16_f32 v211, v170, v171
v_cvt_pk_bf16_f32 v214, v172, v173
v_cvt_pk_bf16_f32 v215, v174, v175
v_mfma_f32_16x16x32_bf16 v[40:43], v[192:195], v[208:211], 0
v_mfma_f32_16x16x32_bf16 v[44:47], v[196:199], v[208:211], 0
v_mfma_f32_16x16x32_bf16 v[48:51], v[200:203], v[212:215], 0
v_mfma_f32_16x16x32_bf16 v[52:55], v[204:207], v[212:215], 0
v_mfma_f32_16x16x32_bf16 v[56:59], v[192:195], v[20:23], 0
v_mfma_f32_16x16x32_bf16 v[60:63], v[196:199], v[20:23], 0
v_mfma_f32_16x16x32_bf16 v[64:67], v[200:203], v[20:23], 0
v_mfma_f32_16x16x32_bf16 v[68:71], v[204:207], v[20:23], 0
s_nop 0
s_nop 0
v_cvt_pk_bf16_f32 v72, v40, v41
v_cvt_pk_bf16_f32 v73, v42, v43
v_cvt_pk_bf16_f32 v74, v44, v45
v_cvt_pk_bf16_f32 v75, v46, v47
v_cvt_pk_bf16_f32 v80, v48, v49
v_cvt_pk_bf16_f32 v81, v50, v51
v_cvt_pk_bf16_f32 v82, v52, v53
v_cvt_pk_bf16_f32 v83, v54, v55
s_cmp_eq_u32 s56, 0
s_cbranch_scc1 Lslow_3
buffer_store_dwordx4 v[72:75], v248, s[44:47], 0 offen
buffer_store_dwordx4 v[80:83], v248, s[44:47], s5 offen
s_branch Lpub_4
Lslow_3:
s_nop 0
buffer_store_dwordx4 v[72:75], v248, s[44:47], 0 offen sc1
buffer_store_dwordx4 v[80:83], v248, s[44:47], s5 offen sc1
Lpub_4:
v_cvt_pk_bf16_f32 v76, v56, v57
v_cvt_pk_bf16_f32 v77, v58, v59
v_cvt_pk_bf16_f32 v78, v60, v61
v_cvt_pk_bf16_f32 v79, v62, v63
v_cvt_pk_bf16_f32 v84, v64, v65
v_cvt_pk_bf16_f32 v85, v66, v67
v_cvt_pk_bf16_f32 v86, v68, v69
v_cvt_pk_bf16_f32 v87, v70, v71
s_mov_b64 exec, s[76:77]
s_cmp_eq_u32 s56, 0
s_cbranch_scc1 Lslow_5
buffer_store_dwordx4 v[76:79], v249, s[44:47], 0 offen
buffer_store_dwordx4 v[84:87], v249, s[44:47], 0 offen offset:1024
s_branch Lpub_6
Lslow_5:
buffer_store_dwordx4 v[76:79], v249, s[44:47], 0 offen sc1
buffer_store_dwordx4 v[84:87], v249, s[44:47], 0 offen offset:1024 sc1
Lpub_6:
s_mov_b64 exec, -1
v_add_u32 v34, 0x10000, v12
v_add_u32 v35, 0x10000, v13
s_waitcnt vmcnt(0)
s_mov_b64 exec, 1
s_cmp_eq_u32 s56, 0
s_cbranch_scc1 Lslow_7
buffer_store_dword v9, v250, s[44:47], 0 offen offset:0
buffer_store_dword v9, v250, s[44:47], 0 offen offset:32
s_branch Lpub_8
Lslow_7:
buffer_store_dword v9, v250, s[44:47], 0 offen offset:0 sc1
buffer_store_dword v9, v250, s[44:47], 0 offen offset:32 sc1
Lpub_8:
s_mov_b64 exec, -1
s_nop 0
v_add_u32 v10, 7168, v8
v_add_u32 v11, 14336, v8
v_add_u32 v255, 21504, v8
s_barrier
s_nop 0
ds_read_b64_tr_b16 v[128:129], v34 offset:0
ds_read_b64_tr_b16 v[130:131], v34 offset:512
ds_read_b64_tr_b16 v[132:133], v35 offset:0
ds_read_b64_tr_b16 v[134:135], v35 offset:512
ds_read_b64_tr_b16 v[136:137], v34 offset:4096
ds_read_b64_tr_b16 v[138:139], v34 offset:4608
ds_read_b64_tr_b16 v[140:141], v35 offset:4096
ds_read_b64_tr_b16 v[142:143], v35 offset:4608
s_waitcnt lgkmcnt(0)
v_mfma_f32_16x16x32_bf16 v[104:107], v[128:131], a[0:3], 0
v_and_b32 v234, 7, v0
v_mfma_f32_16x16x32_bf16 v[108:111], v[128:131], a[64:67], 0
ds_read_b64_tr_b16 v[144:145], v34 offset:8192
v_lshlrev_b32_e64 v234, 2, v234
v_mfma_f32_16x16x32_bf16 v[120:123], v[128:131], v[20:23], 0
ds_read_b64_tr_b16 v[146:147], v34 offset:8704
v_lshlrev_b32_e64 v235, 4, v3
s_mul_i32 s64, s48, 720896
v_mfma_f32_16x16x32_bf16 v[112:115], v[132:135], a[0:3], 0
s_add_u32 s64, s64, 6291456
v_mfma_f32_16x16x32_bf16 v[116:119], v[132:135], a[64:67], 0
ds_read_b64_tr_b16 v[148:149], v35 offset:8192
s_lshl_b32 s66, s48, 5
v_mfma_f32_16x16x32_bf16 v[124:127], v[132:135], v[20:23], 0
ds_read_b64_tr_b16 v[150:151], v35 offset:8704
s_lshl_b32 s62, s50, 2
s_add_u32 s62, s62, s49
v_mfma_f32_16x16x32_bf16 v[104:107], v[136:139], a[4:7], v[104:107]
s_add_u32 s63, s66, s62
v_mfma_f32_16x16x32_bf16 v[108:111], v[136:139], a[68:71], v[108:111]
ds_read_b64_tr_b16 v[152:153], v34 offset:12288
s_lshl_b32 s65, s63, 5
v_mfma_f32_16x16x32_bf16 v[120:123], v[136:139], v[20:23], v[120:123]
ds_read_b64_tr_b16 v[154:155], v34 offset:12800
s_add_u32 s65, s65, 16384
v_add_u32 v232, s65, v234
v_mfma_f32_16x16x32_bf16 v[112:115], v[140:143], a[4:7], v[112:115]
v_accvgpr_write_b32 a131, v232
v_mfma_f32_16x16x32_bf16 v[116:119], v[140:143], a[68:71], v[116:119]
ds_read_b64_tr_b16 v[156:157], v35 offset:12288
s_lshl_b32 s65, s62, 13
v_mfma_f32_16x16x32_bf16 v[124:127], v[140:143], v[20:23], v[124:127]
ds_read_b64_tr_b16 v[158:159], v35 offset:12800
s_add_u32 s65, s65, s64
s_waitcnt lgkmcnt(0)
v_mfma_f32_16x16x32_bf16 v[104:107], v[144:147], a[8:11], v[104:107]
v_add_u32 v232, s65, v1
v_mfma_f32_16x16x32_bf16 v[108:111], v[144:147], a[72:75], v[108:111]
ds_read_b64_tr_b16 v[128:129], v34 offset:16384
v_accvgpr_write_b32 a132, v232
v_mfma_f32_16x16x32_bf16 v[120:123], v[144:147], v[20:23], v[120:123]
ds_read_b64_tr_b16 v[130:131], v34 offset:16896
v_lshrrev_b32 v233, 2, v0
v_lshlrev_b32 v233, 7, v233
v_mfma_f32_16x16x32_bf16 v[112:115], v[148:151], a[8:11], v[112:115]
v_and_b32_e64 v232, 3, v0
v_mfma_f32_16x16x32_bf16 v[116:119], v[148:151], a[72:75], v[116:119]
ds_read_b64_tr_b16 v[132:133], v35 offset:16384
v_lshl_add_u32 v233, v232, 4, v233
v_mfma_f32_16x16x32_bf16 v[124:127], v[148:151], v[20:23], v[124:127]
ds_read_b64_tr_b16 v[134:135], v35 offset:16896
v_mov_b32 v232, 0x40000000
v_cmp_gt_u32 vcc, 32, v0
v_mfma_f32_16x16x32_bf16 v[104:107], v[152:155], a[12:15], v[104:107]
s_nop 0
v_cndmask_b32 v233, v232, v233, vcc
v_mfma_f32_16x16x32_bf16 v[108:111], v[152:155], a[76:79], v[108:111]
ds_read_b64_tr_b16 v[136:137], v34 offset:20480
s_lshl_b32 s65, s63, 10
v_mfma_f32_16x16x32_bf16 v[120:123], v[152:155], v[20:23], v[120:123]
ds_read_b64_tr_b16 v[138:139], v34 offset:20992
s_add_u32 s65, s65, 393216
v_add_u32 v232, s65, v233
v_mfma_f32_16x16x32_bf16 v[112:115], v[156:159], a[12:15], v[112:115]
v_accvgpr_write_b32 a133, v232
v_mfma_f32_16x16x32_bf16 v[116:119], v[156:159], a[76:79], v[116:119]
ds_read_b64_tr_b16 v[140:141], v35 offset:20480
s_lshl_b32 s63, s62, 3
v_mfma_f32_16x16x32_bf16 v[124:127], v[156:159], v[20:23], v[124:127]
ds_read_b64_tr_b16 v[142:143], v35 offset:20992
s_add_u32 s63, s63, s48
s_waitcnt lgkmcnt(0)
v_mfma_f32_16x16x32_bf16 v[104:107], v[128:131], a[16:19], v[104:107]
s_lshl_b32 s65, s63, 10
v_mfma_f32_16x16x32_bf16 v[108:111], v[128:131], a[80:83], v[108:111]
ds_read_b64_tr_b16 v[144:145], v34 offset:24576
s_add_u32 s65, s65, 655360
v_mfma_f32_16x16x32_bf16 v[120:123], v[128:131], v[20:23], v[120:123]
ds_read_b64_tr_b16 v[146:147], v34 offset:25088
v_add_u32_e64 v232, s65, v1
v_accvgpr_write_b32 a134, v232
v_mfma_f32_16x16x32_bf16 v[112:115], v[132:135], a[16:19], v[112:115]
s_lshl_b32 s65, s63, 7
v_mfma_f32_16x16x32_bf16 v[116:119], v[132:135], a[80:83], v[116:119]
ds_read_b64_tr_b16 v[148:149], v35 offset:24576
s_add_u32 s65, s65, 917504
v_mfma_f32_16x16x32_bf16 v[124:127], v[132:135], v[20:23], v[124:127]
ds_read_b64_tr_b16 v[150:151], v35 offset:25088
v_add_u32 v232, s65, v1
v_accvgpr_write_b32 a135, v232
v_mfma_f32_16x16x32_bf16 v[104:107], v[136:139], a[20:23], v[104:107]
s_lshl_b32 s65, s62, 7
v_mfma_f32_16x16x32_bf16 v[108:111], v[136:139], a[84:87], v[108:111]
ds_read_b64_tr_b16 v[152:153], v34 offset:28672
s_lshl_b32 s63, s48, 2
v_mfma_f32_16x16x32_bf16 v[120:123], v[136:139], v[20:23], v[120:123]
ds_read_b64_tr_b16 v[154:155], v34 offset:29184
s_add_u32 s65, s65, s63
s_add_u32 s65, s65, 8192
v_mfma_f32_16x16x32_bf16 v[112:115], v[140:143], a[20:23], v[112:115]
v_mov_b32 v232, s65
v_mfma_f32_16x16x32_bf16 v[116:119], v[140:143], a[84:87], v[116:119]
ds_read_b64_tr_b16 v[156:157], v35 offset:28672
v_accvgpr_write_b32 a136, v232
v_mfma_f32_16x16x32_bf16 v[124:127], v[140:143], v[20:23], v[124:127]
ds_read_b64_tr_b16 v[158:159], v35 offset:29184
s_lshl_b32 s62, s50, 2
s_waitcnt lgkmcnt(0)
v_mfma_f32_16x16x32_bf16 v[104:107], v[144:147], a[24:27], v[104:107]
s_add_u32 s62, s62, s52
v_mfma_f32_16x16x32_bf16 v[108:111], v[144:147], a[88:91], v[108:111]
ds_read_b64_tr_b16 v[128:129], v34 offset:32768
s_lshl_b32 s65, s62, 7
v_mfma_f32_16x16x32_bf16 v[120:123], v[144:147], v[20:23], v[120:123]
ds_read_b64_tr_b16 v[130:131], v34 offset:33280
s_add_u32 s65, s65, 8192
v_add_u32_e64 v232, s65, v234
v_mfma_f32_16x16x32_bf16 v[112:115], v[148:151], a[24:27], v[112:115]
v_accvgpr_write_b32 a137, v232
v_mfma_f32_16x16x32_bf16 v[116:119], v[148:151], a[88:91], v[116:119]
ds_read_b64_tr_b16 v[132:133], v35 offset:32768
s_lshl_b32 s65, s62, 13
s_add_u32 s65, s65, 655360
v_mfma_f32_16x16x32_bf16 v[124:127], v[148:151], v[20:23], v[124:127]
ds_read_b64_tr_b16 v[134:135], v35 offset:33280
v_add_u32 v232, s65, v1
v_mfma_f32_16x16x32_bf16 v[104:107], v[152:155], a[28:31], v[104:107]
v_accvgpr_write_b32 a138, v232
s_lshl_b32 s65, s62, 10
v_mfma_f32_16x16x32_bf16 v[108:111], v[152:155], a[92:95], v[108:111]
ds_read_b64_tr_b16 v[136:137], v34 offset:36864
s_add_u32 s65, s65, 917504
v_mfma_f32_16x16x32_bf16 v[120:123], v[152:155], v[20:23], v[120:123]
ds_read_b64_tr_b16 v[138:139], v34 offset:37376
v_add_u32 v232, s65, v233
v_accvgpr_write_b32 a139, v232
v_mfma_f32_16x16x32_bf16 v[112:115], v[156:159], a[28:31], v[112:115]
v_accvgpr_read_b32 v248, a131
v_mfma_f32_16x16x32_bf16 v[116:119], v[156:159], a[92:95], v[116:119]
ds_read_b64_tr_b16 v[140:141], v35 offset:36864
v_accvgpr_read_b32 v249, a132
v_accvgpr_read_b32 v250, a133
v_mfma_f32_16x16x32_bf16 v[124:127], v[156:159], v[20:23], v[124:127]
s_branch Lpg_2_n
.p2align 12
Lpg_2:
s_setpc_b64 s[100:101]
s_nop 0
Lpg_2_n:
ds_read_b64_tr_b16 v[142:143], v35 offset:37376
s_cmp_lg_u32 s52, 0
s_nop 5
s_cbranch_scc1 Lred_9
s_movk_i32 s61, 1
s_cmp_lg_u32 s57, 0
s_cbranch_scc1 Lpoll_10
s_mov_b32 s61, 0x8000
Lpoll_10:
buffer_load_dword v161, v248, s[44:47], 0 offen offset:0 sc1
s_waitcnt vmcnt(0)
v_cmp_ne_u32 vcc, s55, v161
s_cbranch_vccz Lpd_11
s_sub_u32 s61, s61, 1
s_cmp_lg_u32 s61, 0
s_cbranch_scc1 Lpoll_10
s_mov_b32 s57, 1
Lpd_11:
s_nop 0
v_accvgpr_read_b32 v251, a134
v_accvgpr_read_b32 v252, a135
v_accvgpr_read_b32 v253, a136
buffer_load_dwordx4 v[208:211], v250, s[44:47], 0 offen sc1
buffer_load_dwordx4 v[176:179], v249, s[44:47], 0 offen offset:0 sc1
buffer_load_dwordx4 v[180:183], v249, s[44:47], 0 offen offset:1024 sc1
buffer_load_dwordx4 v[184:187], v249, s[44:47], 0 offen offset:2048 sc1
buffer_load_dwordx4 v[188:191], v249, s[44:47], 0 offen offset:3072 sc1
buffer_load_dwordx4 v[192:195], v249, s[44:47], s4 offen offset:0 sc1
buffer_load_dwordx4 v[196:199], v249, s[44:47], s4 offen offset:1024 sc1
buffer_load_dwordx4 v[200:203], v249, s[44:47], s4 offen offset:2048 sc1
buffer_load_dwordx4 v[204:207], v249, s[44:47], s4 offen offset:3072 sc1
v_accvgpr_read_b32 v214, a168
v_accvgpr_read_b32 v215, a169
v_mov_b32 v212, 0
v_mov_b32 v213, 0
v_mov_b32 v216, 0
v_mov_b32 v217, 0
s_waitcnt vmcnt(8)
s_nop 0
v_mfma_f32_16x16x32_bf16 v[48:51], v[214:217], v[208:211], 0
v_mfma_f32_16x16x32_bf16 v[52:55], v[212:215], v[208:211], 0
s_waitcnt vmcnt(7)
v_mfma_f32_16x16x32_bf16 v[40:43], v[26:29], v[176:179], 0
v_mfma_f32_16x16x32_bf16 v[44:47], v[24:27], v[176:179], 0
s_waitcnt vmcnt(6)
v_mfma_f32_16x16x32_bf16 v[40:43], v[26:29], v[180:183], v[40:43]
v_mfma_f32_16x16x32_bf16 v[44:47], v[24:27], v[180:183], v[44:47]
s_nop 0
s_nop 0
v_add_f32_dpp v48, v48, v48 row_ror:4 row_mask:0xf bank_mask:0xf
v_add_f32_dpp v49, v49, v49 row_ror:4 row_mask:0xf bank_mask:0xf
v_add_f32_dpp v50, v50, v50 row_ror:4 row_mask:0xf bank_mask:0xf
v_add_f32_dpp v51, v51, v51 row_ror:4 row_mask:0xf bank_mask:0xf
v_add_f32_dpp v52, v52, v52 row_ror:4 row_mask:0xf bank_mask:0xf
v_add_f32_dpp v53, v53, v53 row_ror:4 row_mask:0xf bank_mask:0xf
v_add_f32_dpp v54, v54, v54 row_ror:4 row_mask:0xf bank_mask:0xf
v_add_f32_dpp v55, v55, v55 row_ror:4 row_mask:0xf bank_mask:0xf
s_waitcnt vmcnt(5)
v_mfma_f32_16x16x32_bf16 v[40:43], v[26:29], v[184:187], v[40:43]
v_mfma_f32_16x16x32_bf16 v[44:47], v[24:27], v[184:187], v[44:47]
s_waitcnt vmcnt(4)
v_mfma_f32_16x16x32_bf16 v[40:43], v[26:29], v[188:191], v[40:43]
v_mfma_f32_16x16x32_bf16 v[44:47], v[24:27], v[188:191], v[44:47]
v_add_f32_dpp v48, v48, v48 row_ror:8 row_mask:0xf bank_mask:0xf
v_add_f32_dpp v49, v49, v49 row_ror:8 row_mask:0xf bank_mask:0xf
v_add_f32_dpp v50, v50, v50 row_ror:8 row_mask:0xf bank_mask:0xf
v_add_f32_dpp v51, v51, v51 row_ror:8 row_mask:0xf bank_mask:0xf
v_add_f32_dpp v52, v52, v52 row_ror:8 row_mask:0xf bank_mask:0xf
v_add_f32_dpp v53, v53, v53 row_ror:8 row_mask:0xf bank_mask:0xf
v_add_f32_dpp v54, v54, v54 row_ror:8 row_mask:0xf bank_mask:0xf
v_add_f32_dpp v55, v55, v55 row_ror:8 row_mask:0xf bank_mask:0xf
s_waitcnt vmcnt(3)
v_mfma_f32_16x16x32_bf16 v[40:43], v[26:29], v[192:195], v[40:43]
v_mfma_f32_16x16x32_bf16 v[44:47], v[24:27], v[192:195], v[44:47]
s_waitcnt vmcnt(2)
v_mfma_f32_16x16x32_bf16 v[40:43], v[26:29], v[196:199], v[40:43]
v_mfma_f32_16x16x32_bf16 v[44:47], v[24:27], v[196:199], v[44:47]
v_cvt_pk_bf16_f32 v60, v48, v49
v_cvt_pk_bf16_f32 v61, v50, v51
v_cvt_pk_bf16_f32 v62, v52, v53
v_cvt_pk_bf16_f32 v63, v54, v55
s_waitcnt vmcnt(1)
v_mfma_f32_16x16x32_bf16 v[40:43], v[26:29], v[200:203], v[40:43]
v_mfma_f32_16x16x32_bf16 v[44:47], v[24:27], v[200:203], v[44:47]
s_waitcnt vmcnt(0)
s_barrier
v_mfma_f32_16x16x32_bf16 v[40:43], v[26:29], v[204:207], v[40:43]
v_mfma_f32_16x16x32_bf16 v[44:47], v[24:27], v[204:207], v[44:47]
s_nop 6
v_cvt_pk_bf16_f32 v56, v40, v41
v_cvt_pk_bf16_f32 v57, v42, v43
v_cvt_pk_bf16_f32 v58, v44, v45
v_cvt_pk_bf16_f32 v59, v46, v47
buffer_store_dwordx4 v[56:59], v251, s[44:47], 0 offen sc1
s_mov_b64 exec, 15
buffer_store_dwordx4 v[60:63], v252, s[44:47], 0 offen sc1
s_mov_b64 exec, -1
s_nop 0
Lred_9:
s_waitcnt lgkmcnt(0)
v_mfma_f32_16x16x32_bf16 v[104:107], v[128:131], a[32:35], v[104:107]
v_mfma_f32_16x16x32_bf16 v[108:111], v[128:131], a[96:99], v[108:111]
ds_read_b64_tr_b16 v[144:145], v34 offset:40960
v_mfma_f32_16x16x32_bf16 v[120:123], v[128:131], v[20:23], v[120:123]
ds_read_b64_tr_b16 v[146:147], v34 offset:41472
v_mfma_f32_16x16x32_bf16 v[112:115], v[132:135], a[32:35], v[112:115]
v_mfma_f32_16x16x32_bf16 v[116:119], v[132:135], a[96:99], v[116:119]
ds_read_b64_tr_b16 v[148:149], v35 offset:40960
v_mfma_f32_16x16x32_bf16 v[124:127], v[132:135], v[20:23], v[124:127]
ds_read_b64_tr_b16 v[150:151], v35 offset:41472
v_mfma_f32_16x16x32_bf16 v[104:107], v[136:139], a[36:39], v[104:107]
v_mfma_f32_16x16x32_bf16 v[108:111], v[136:139], a[100:103], v[108:111]
ds_read_b64_tr_b16 v[152:153], v34 offset:45056
v_mfma_f32_16x16x32_bf16 v[120:123], v[136:139], v[20:23], v[120:123]
ds_read_b64_tr_b16 v[154:155], v34 offset:45568
v_mfma_f32_16x16x32_bf16 v[112:115], v[140:143], a[36:39], v[112:115]
v_mfma_f32_16x16x32_bf16 v[116:119], v[140:143], a[100:103], v[116:119]
ds_read_b64_tr_b16 v[156:157], v35 offset:45056
v_mfma_f32_16x16x32_bf16 v[124:127], v[140:143], v[20:23], v[124:127]
ds_read_b64_tr_b16 v[158:159], v35 offset:45568
s_waitcnt lgkmcnt(0)
v_mfma_f32_16x16x32_bf16 v[104:107], v[144:147], a[40:43], v[104:107]
v_mfma_f32_16x16x32_bf16 v[108:111], v[144:147], a[104:107], v[108:111]
ds_read_b64_tr_b16 v[128:129], v34 offset:49152
v_mfma_f32_16x16x32_bf16 v[120:123], v[144:147], v[20:23], v[120:123]
ds_read_b64_tr_b16 v[130:131], v34 offset:49664
v_mfma_f32_16x16x32_bf16 v[112:115], v[148:151], a[40:43], v[112:115]
v_mfma_f32_16x16x32_bf16 v[116:119], v[148:151], a[104:107], v[116:119]
ds_read_b64_tr_b16 v[132:133], v35 offset:49152
v_mfma_f32_16x16x32_bf16 v[124:127], v[148:151], v[20:23], v[124:127]
ds_read_b64_tr_b16 v[134:135], v35 offset:49664
v_mfma_f32_16x16x32_bf16 v[104:107], v[152:155], a[44:47], v[104:107]
v_mfma_f32_16x16x32_bf16 v[108:111], v[152:155], a[108:111], v[108:111]
ds_read_b64_tr_b16 v[136:137], v34 offset:53248
v_mfma_f32_16x16x32_bf16 v[120:123], v[152:155], v[20:23], v[120:123]
ds_read_b64_tr_b16 v[138:139], v34 offset:53760
v_mfma_f32_16x16x32_bf16 v[112:115], v[156:159], a[44:47], v[112:115]
v_mfma_f32_16x16x32_bf16 v[116:119], v[156:159], a[108:111], v[116:119]
ds_read_b64_tr_b16 v[140:141], v35 offset:53248
v_mfma_f32_16x16x32_bf16 v[124:127], v[156:159], v[20:23], v[124:127]
ds_read_b64_tr_b16 v[142:143], v35 offset:53760
s_waitcnt lgkmcnt(0)
v_mfma_f32_16x16x32_bf16 v[104:107], v[128:131], a[48:51], v[104:107]
v_mfma_f32_16x16x32_bf16 v[108:111], v[128:131], a[112:115], v[108:111]
ds_read_b64_tr_b16 v[144:145], v34 offset:57344
v_mfma_f32_16x16x32_bf16 v[120:123], v[128:131], v[20:23], v[120:123]
ds_read_b64_tr_b16 v[146:147], v34 offset:57856
v_mfma_f32_16x16x32_bf16 v[112:115], v[132:135], a[48:51], v[112:115]
v_mfma_f32_16x16x32_bf16 v[116:119], v[132:135], a[112:115], v[116:119]
ds_read_b64_tr_b16 v[148:149], v35 offset:57344
v_mfma_f32_16x16x32_bf16 v[124:127], v[132:135], v[20:23], v[124:127]
ds_read_b64_tr_b16 v[150:151], v35 offset:57856
v_mfma_f32_16x16x32_bf16 v[104:107], v[136:139], a[52:55], v[104:107]
v_mfma_f32_16x16x32_bf16 v[108:111], v[136:139], a[116:119], v[108:111]
ds_read_b64_tr_b16 v[152:153], v34 offset:61440
v_mfma_f32_16x16x32_bf16 v[120:123], v[136:139], v[20:23], v[120:123]
ds_read_b64_tr_b16 v[154:155], v34 offset:61952
v_mfma_f32_16x16x32_bf16 v[112:115], v[140:143], a[52:55], v[112:115]
v_mfma_f32_16x16x32_bf16 v[116:119], v[140:143], a[116:119], v[116:119]
ds_read_b64_tr_b16 v[156:157], v35 offset:61440
v_mfma_f32_16x16x32_bf16 v[124:127], v[140:143], v[20:23], v[124:127]
ds_read_b64_tr_b16 v[158:159], v35 offset:61952
s_waitcnt lgkmcnt(0)
v_mfma_f32_16x16x32_bf16 v[104:107], v[144:147], a[56:59], v[104:107]
v_mfma_f32_16x16x32_bf16 v[108:111], v[144:147], a[120:123], v[108:111]
s_lshl_b32 s64, s59, 14
v_mfma_f32_16x16x32_bf16 v[120:123], v[144:147], v[20:23], v[120:123]
s_lshl_b32 s63, s50, 7
v_mfma_f32_16x16x32_bf16 v[112:115], v[148:151], a[56:59], v[112:115]
s_add_u32 s64, s64, s63
v_mfma_f32_16x16x32_bf16 v[116:119], v[148:151], a[120:123], v[116:119]
v_lshlrev_b32_e64 v236, 10, v2
v_mfma_f32_16x16x32_bf16 v[124:127], v[148:151], v[20:23], v[124:127]
v_mfma_f32_16x16x32_bf16 v[104:107], v[152:155], a[60:63], v[104:107]
v_lshl_add_u32 v236, v3, 3, v236
v_mfma_f32_16x16x32_bf16 v[108:111], v[152:155], a[124:127], v[108:111]
buffer_load_dwordx2 v[240:241], v236, s[8:11], s64 offen offset:0
v_mfma_f32_16x16x32_bf16 v[120:123], v[152:155], v[20:23], v[120:123]
buffer_load_dwordx2 v[242:243], v236, s[8:11], s64 offen offset:32
v_mfma_f32_16x16x32_bf16 v[112:115], v[156:159], a[60:63], v[112:115]
buffer_load_dwordx2 v[244:245], v236, s[8:11], s64 offen offset:64
v_mfma_f32_16x16x32_bf16 v[116:119], v[156:159], a[124:127], v[116:119]
buffer_load_dwordx2 v[246:247], v236, s[8:11], s64 offen offset:96
v_mfma_f32_16x16x32_bf16 v[124:127], v[156:159], v[20:23], v[124:127]
s_cmp_eq_u32 s52, 0
s_nop 6
s_cbranch_scc1 L_q0
s_barrier
s_lshl_b32 s63, s49, 2
s_add_u32 s62, s63, s52
s_sub_u32 s62, s62, 1
s_add_u32 s0, s62, 0
s_and_b32 s0, s0, 15
s_lshl_b32 s1, s0, 15
s_lshl_b32 s0, s0, 12
s_add_u32 m0, s0, 0
s_nop 0
s_nop 0
buffer_load_dwordx4 v8, s[20:23], s1 offen offset:0 lds
buffer_load_dwordx4 v10, s[20:23], s1 offen offset:1024 lds
buffer_load_dwordx4 v11, s[20:23], s1 offen offset:2048 lds
buffer_load_dwordx4 v255, s[20:23], s1 offen offset:3072 lds
L_q0:
v_mov_b32 v232, v36
v_mov_b32 v233, v36
v_mov_b32 v234, v37
v_mov_b32 v235, v37
v_mov_b32 v236, v38
v_mov_b32 v237, v38
v_mov_b32 v238, v39
v_mov_b32 v239, v39
v_pk_fma_f32 v[160:161], v[120:121], v[232:233], v[104:105] neg_lo:[1,0,0] neg_hi:[1,0,0]
v_pk_fma_f32 v[162:163], v[122:123], v[232:233], v[106:107] neg_lo:[1,0,0] neg_hi:[1,0,0]
v_pk_fma_f32 v[176:177], v[120:121], v[234:235], v[108:109] neg_lo:[1,0,0] neg_hi:[1,0,0]
v_pk_fma_f32 v[178:179], v[122:123], v[234:235], v[110:111] neg_lo:[1,0,0] neg_hi:[1,0,0]
v_pk_fma_f32 v[192:193], v[124:125], v[232:233], v[112:113] neg_lo:[1,0,0] neg_hi:[1,0,0]
v_pk_fma_f32 v[194:195], v[126:127], v[232:233], v[114:115] neg_lo:[1,0,0] neg_hi:[1,0,0]
v_pk_fma_f32 v[208:209], v[124:125], v[234:235], v[116:117] neg_lo:[1,0,0] neg_hi:[1,0,0]
v_pk_fma_f32 v[210:211], v[126:127], v[234:235], v[118:119] neg_lo:[1,0,0] neg_hi:[1,0,0]
v_pk_mul_f32 v[160:161], v[160:161], v[236:237]
v_pk_mul_f32 v[162:163], v[162:163], v[236:237]
v_pk_mul_f32 v[176:177], v[176:177], v[238:239]
v_pk_mul_f32 v[178:179], v[178:179], v[238:239]
v_pk_mul_f32 v[192:193], v[192:193], v[236:237]
v_pk_mul_f32 v[194:195], v[194:195], v[236:237]
v_pk_mul_f32 v[208:209], v[208:209], v[238:239]
v_pk_mul_f32 v[210:211], v[210:211], v[238:239]
v_cvt_pk_bf16_f32 v164, v160, v161
v_cvt_pk_bf16_f32 v165, v162, v163
v_cvt_pk_bf16_f32 v180, v176, v177
v_cvt_pk_bf16_f32 v181, v178, v179
v_cvt_pk_bf16_f32 v196, v192, v193
v_cvt_pk_bf16_f32 v197, v194, v195
v_cvt_pk_bf16_f32 v212, v208, v209
v_cvt_pk_bf16_f32 v213, v210, v211
v_mfma_f32_16x16x16_bf16 v[160:163], v[30:31], v[164:165], 0
v_mfma_f32_16x16x16_bf16 v[176:179], v[30:31], v[180:181], 0
v_mfma_f32_16x16x16_bf16 v[192:195], v[32:33], v[196:197], 0
v_mfma_f32_16x16x16_bf16 v[208:211], v[32:33], v[212:213], 0
s_nop 4
s_nop 0
v_max3_f32 v164, v160, v161, v162
v_max3_f32 v165, -v160, -v161, -v162
v_max3_f32 v180, v176, v177, v178
v_max3_f32 v181, -v176, -v177, -v178
v_max3_f32 v196, v192, v193, v194
v_max3_f32 v197, -v192, -v193, -v194
v_max3_f32 v212, v208, v209, v210
v_max3_f32 v213, -v208, -v209, -v210
v_max_f32_e64 v164, v164, v163
v_max_f32_e64 v165, v165, -v163
s_cmp_lg_u32 s52, 0
s_nop 0
s_cbranch_scc1 Lred_12
s_waitcnt vmcnt(0)
s_mov_b64 exec, 1
buffer_store_dword v9, v253, s[44:47], 0 offen offset:0 sc1
s_mov_b64 exec, -1
s_nop 0
Lred_12:
v_max_f32 v180, v180, v179
v_max_f32_e64 v181, v181, -v179
v_max_f32_e64 v196, v196, v195
v_max_f32_e64 v197, v197, -v195
v_max_f32_e64 v212, v212, v211
v_max_f32_e64 v213, v213, -v211
v_permlane32_swap_b32 v164, v165
v_permlane32_swap_b32 v180, v181
v_permlane32_swap_b32 v196, v197
v_permlane32_swap_b32 v212, v213
v_max_f32 v164, v164, v165
v_max_f32 v180, v180, v181
v_max_f32 v196, v196, v197
v_max_f32 v212, v212, v213
v_mov_b32 v165, v164
v_mov_b32 v181, v180
v_mov_b32 v197, v196
v_mov_b32 v213, v212
v_permlane16_swap_b32 v164, v165
v_permlane16_swap_b32 v180, v181
v_permlane16_swap_b32 v196, v197
v_permlane16_swap_b32 v212, v213
v_max_f32 v164, v164, v165
v_max_f32 v180, v180, v181
v_max_f32 v196, v196, v197
v_max_f32 v212, v212, v213
v_mov_b32 v165, v164
v_mov_b32 v181, v180
v_mov_b32 v197, v196
v_mov_b32 v213, v212
v_permlane32_swap_b32 v164, v165
v_permlane32_swap_b32 v180, v181
v_permlane32_swap_b32 v196, v197
v_permlane32_swap_b32 v212, v213
v_mul_f32 v164, s78, v164
v_mul_f32 v165, s78, v165
v_mul_f32 v180, s78, v180
v_mul_f32 v181, s78, v181
v_mul_f32 v196, s78, v196
v_mul_f32 v197, s78, v197
v_mul_f32 v212, s78, v212
v_mul_f32 v213, s78, v213
v_fma_f32 v168, v160, s78, -v164
v_fma_f32 v169, v160, s79, -v165
v_fma_f32 v184, v176, s78, -v180
v_fma_f32 v185, v176, s79, -v181
v_fma_f32 v200, v192, s78, -v196
v_fma_f32 v201, v192, s79, -v197
v_fma_f32 v216, v208, s78, -v212
v_fma_f32 v217, v208, s79, -v213
v_fma_f32 v170, v161, s78, -v164
v_fma_f32 v171, v161, s79, -v165
v_fma_f32 v186, v177, s78, -v180
v_fma_f32 v187, v177, s79, -v181
v_fma_f32 v202, v193, s78, -v196
v_fma_f32 v203, v193, s79, -v197
v_fma_f32 v218, v209, s78, -v212
v_fma_f32 v219, v209, s79, -v213
v_fma_f32 v172, v162, s78, -v164
v_fma_f32 v173, v162, s79, -v165
v_fma_f32 v188, v178, s78, -v180
v_fma_f32 v189, v178, s79, -v181
v_fma_f32 v204, v194, s78, -v196
v_fma_f32 v205, v194, s79, -v197
v_fma_f32 v220, v210, s78, -v212
v_fma_f32 v221, v210, s79, -v213
v_fma_f32 v174, v163, s78, -v164
v_fma_f32 v175, v163, s79, -v165
v_fma_f32 v190, v179, s78, -v180
v_fma_f32 v191, v179, s79, -v181
v_fma_f32 v206, v195, s78, -v196
v_fma_f32 v207, v195, s79, -v197
v_fma_f32 v222, v211, s78, -v212
v_fma_f32 v223, v211, s79, -v213
v_exp_f32 v168, v168
v_exp_f32 v184, v184
v_exp_f32 v200, v200
v_exp_f32 v216, v216
v_exp_f32 v169, v169
v_exp_f32 v185, v185
v_exp_f32 v201, v201
v_exp_f32 v217, v217
v_exp_f32 v170, v170
v_exp_f32 v186, v186
v_exp_f32 v202, v202
v_exp_f32 v218, v218
v_exp_f32 v171, v171
v_exp_f32 v187, v187
v_exp_f32 v203, v203
v_exp_f32 v219, v219
v_exp_f32 v172, v172
v_exp_f32 v188, v188
v_exp_f32 v204, v204
v_exp_f32 v220, v220
v_exp_f32 v173, v173
v_exp_f32 v189, v189
v_exp_f32 v205, v205
v_exp_f32 v221, v221
v_exp_f32 v174, v174
v_exp_f32 v190, v190
v_exp_f32 v206, v206
v_exp_f32 v222, v222
v_exp_f32 v175, v175
v_exp_f32 v191, v191
v_exp_f32 v207, v207
v_exp_f32 v223, v223
v_pk_add_f32 v[160:161], v[168:169], v[170:171]
v_pk_add_f32 v[162:163], v[172:173], v[174:175]
v_pk_add_f32 v[176:177], v[184:185], v[186:187]
v_pk_add_f32 v[178:179], v[188:189], v[190:191]
v_pk_add_f32 v[192:193], v[200:201], v[202:203]
v_pk_add_f32 v[194:195], v[204:205], v[206:207]
v_pk_add_f32 v[208:209], v[216:217], v[218:219]
v_pk_add_f32 v[210:211], v[220:221], v[222:223]
v_pk_add_f32 v[160:161], v[160:161], v[162:163]
v_pk_add_f32 v[176:177], v[176:177], v[178:179]
v_pk_add_f32 v[192:193], v[192:193], v[194:195]
v_pk_add_f32 v[208:209], v[208:209], v[210:211]
v_permlane32_swap_b32 v160, v161
v_permlane32_swap_b32 v176, v177
v_permlane32_swap_b32 v192, v193
v_permlane32_swap_b32 v208, v209
v_add_f32 v160, v160, v161
v_add_f32 v176, v176, v177
v_add_f32 v192, v192, v193
v_add_f32 v208, v208, v209
v_mov_b32 v161, v160
v_mov_b32 v177, v176
v_mov_b32 v193, v192
v_mov_b32 v209, v208
v_permlane16_swap_b32 v160, v161
v_permlane16_swap_b32 v176, v177
v_permlane16_swap_b32 v192, v193
v_permlane16_swap_b32 v208, v209
v_add_f32 v160, v160, v161
v_add_f32 v176, v176, v177
v_add_f32 v192, v192, v193
v_add_f32 v208, v208, v209
v_mov_b32 v161, v160
v_mov_b32 v177, v176
v_mov_b32 v193, v192
v_mov_b32 v209, v208
v_permlane32_swap_b32 v160, v161
v_permlane32_swap_b32 v176, v177
v_permlane32_swap_b32 v192, v193
v_permlane32_swap_b32 v208, v209
v_rcp_f32 v160, v160
v_rcp_f32 v161, v161
v_rcp_f32 v176, v176
v_rcp_f32 v177, v177
v_rcp_f32 v192, v192
v_rcp_f32 v193, v193
v_rcp_f32 v208, v208
v_rcp_f32 v209, v209
v_pk_mul_f32 v[168:169], v[168:169], v[160:161]
v_pk_mul_f32 v[184:185], v[184:185], v[176:177]
v_pk_mul_f32 v[200:201], v[200:201], v[192:193]
v_pk_mul_f32 v[216:217], v[216:217], v[208:209]
v_pk_mul_f32 v[170:171], v[170:171], v[160:161]
v_pk_mul_f32 v[186:187], v[186:187], v[176:177]
v_pk_mul_f32 v[202:203], v[202:203], v[192:193]
v_pk_mul_f32 v[218:219], v[218:219], v[208:209]
v_pk_mul_f32 v[172:173], v[172:173], v[160:161]
v_pk_mul_f32 v[188:189], v[188:189], v[176:177]
v_pk_mul_f32 v[204:205], v[204:205], v[192:193]
v_pk_mul_f32 v[220:221], v[220:221], v[208:209]
v_pk_mul_f32 v[174:175], v[174:175], v[160:161]
v_pk_mul_f32 v[190:191], v[190:191], v[176:177]
v_pk_mul_f32 v[206:207], v[206:207], v[192:193]
v_pk_mul_f32 v[222:223], v[222:223], v[208:209]
v_cvt_pk_bf16_f32 v128, v168, v170
v_cvt_pk_bf16_f32 v129, v172, v174
v_cvt_pk_bf16_f32 v130, v169, v171
v_cvt_pk_bf16_f32 v131, v173, v175
v_cvt_pk_bf16_f32 v132, v184, v186
v_cvt_pk_bf16_f32 v133, v188, v190
v_cvt_pk_bf16_f32 v134, v185, v187
v_cvt_pk_bf16_f32 v135, v189, v191
v_cvt_pk_bf16_f32 v136, v200, v202
v_cvt_pk_bf16_f32 v137, v204, v206
v_cvt_pk_bf16_f32 v138, v201, v203
v_cvt_pk_bf16_f32 v139, v205, v207
v_cvt_pk_bf16_f32 v140, v216, v218
v_cvt_pk_bf16_f32 v141, v220, v222
v_cvt_pk_bf16_f32 v142, v217, v219
v_cvt_pk_bf16_f32 v143, v221, v223
s_cmp_eq_u32 s52, 0
s_nop 0
s_cbranch_scc1 L_qd
s_waitcnt vmcnt(0)
s_lshl_b32 s63, s49, 2
s_add_u32 s62, s63, s52
s_sub_u32 s62, s62, 1
s_add_u32 s0, s62, 3
s_and_b32 s0, s0, 15
s_lshl_b32 s1, s0, 15
s_lshl_b32 s0, s0, 12
s_add_u32 m0, s0, 0
s_nop 0
s_nop 0
buffer_load_dwordx4 v8, s[20:23], s1 offen offset:0 lds
buffer_load_dwordx4 v10, s[20:23], s1 offen offset:1024 lds
buffer_load_dwordx4 v11, s[20:23], s1 offen offset:2048 lds
buffer_load_dwordx4 v255, s[20:23], s1 offen offset:3072 lds
s_add_u32 s0, s62, 6
s_and_b32 s0, s0, 15
s_lshl_b32 s1, s0, 15
s_lshl_b32 s0, s0, 12
s_add_u32 m0, s0, 0
s_nop 0
buffer_load_dwordx4 v8, s[20:23], s1 offen offset:0 lds
buffer_load_dwordx4 v10, s[20:23], s1 offen offset:1024 lds
buffer_load_dwordx4 v11, s[20:23], s1 offen offset:2048 lds
buffer_load_dwordx4 v255, s[20:23], s1 offen offset:3072 lds
s_add_u32 s0, s62, 9
s_and_b32 s0, s0, 15
s_lshl_b32 s1, s0, 15
s_lshl_b32 s0, s0, 12
s_add_u32 m0, s0, 0
s_nop 0
buffer_load_dwordx4 v8, s[20:23], s1 offen offset:0 lds
buffer_load_dwordx4 v10, s[20:23], s1 offen offset:1024 lds
buffer_load_dwordx4 v11, s[20:23], s1 offen offset:2048 lds
buffer_load_dwordx4 v255, s[20:23], s1 offen offset:3072 lds
s_add_u32 s0, s62, 12
s_and_b32 s0, s0, 15
s_lshl_b32 s1, s0, 15
s_lshl_b32 s0, s0, 12
s_add_u32 m0, s0, 0
s_nop 0
buffer_load_dwordx4 v8, s[20:23], s1 offen offset:0 lds
buffer_load_dwordx4 v10, s[20:23], s1 offen offset:1024 lds
buffer_load_dwordx4 v11, s[20:23], s1 offen offset:2048 lds
buffer_load_dwordx4 v255, s[20:23], s1 offen offset:3072 lds
s_add_u32 s0, s62, 15
s_and_b32 s0, s0, 15
s_lshl_b32 s1, s0, 15
s_lshl_b32 s0, s0, 12
s_cmp_lg_u32 s52, 1
s_cbranch_scc1 Lw3s_13
s_add_u32 m0, s0, 0
s_nop 0
buffer_load_dwordx4 v8, s[20:23], s1 offen offset:0 lds
buffer_load_dwordx4 v10, s[20:23], s1 offen offset:1024 lds
buffer_load_dwordx4 v11, s[20:23], s1 offen offset:2048 lds
buffer_load_dwordx4 v255, s[20:23], s1 offen offset:3072 lds
Lw3s_13:
L_qd:
s_getpc_b64 s[92:93]
Lpc_14:
s_cmp_eq_u32 s52, 1
s_cbranch_scc0 Ltouch_15
s_add_u32 s98, s92, Lpg_3-Lpc_14
s_addc_u32 s99, s93, 0
s_swappc_b64 s[100:101], s[98:99]
s_add_u32 s98, s92, Lpg_6-Lpc_14
s_addc_u32 s99, s93, 0
s_swappc_b64 s[100:101], s[98:99]
Ltouch_15:
s_cmp_eq_u32 s52, 2
s_cbranch_scc0 Ltouch_16
s_add_u32 s98, s92, Lpg_4-Lpc_14
s_addc_u32 s99, s93, 0
s_swappc_b64 s[100:101], s[98:99]
s_add_u32 s98, s92, Lpg_7-Lpc_14
s_addc_u32 s99, s93, 0
s_swappc_b64 s[100:101], s[98:99]
Ltouch_16:
s_cmp_eq_u32 s52, 3
s_cbranch_scc0 Ltouch_17
s_add_u32 s98, s92, Lpg_5-Lpc_14
s_addc_u32 s99, s93, 0
s_swappc_b64 s[100:101], s[98:99]
s_add_u32 s98, s92, Lpg_8-Lpc_14
s_addc_u32 s99, s93, 0
s_swappc_b64 s[100:101], s[98:99]
Ltouch_17:
v_and_b32 v250, 7, v0
v_lshlrev_b32 v250, 2, v250
v_lshlrev_b32 v251, 4, v3
s_lshl_b32 s62, s51, 2
s_lshl_b32 s63, s53, 1
s_add_u32 s62, s62, s63
s_lshl_b32 s63, s50, 1
s_add_u32 s63, s63, s54
s_lshl_b32 s65, s62, 14
s_lshl_b32 s66, s63, 10
s_add_u32 s65, s65, s66
s_add_u32 s65, s65, 2097152
s_lshl_b32 s66, s54, 14
s_add_u32 s67, s65, s66
v_add_u32_e64 v248, s67, v1
v_accvgpr_write_b32 a140, v248
s_xor_b32 s66, s66, 0x4000
s_add_u32 s67, s65, s66
v_add_u32 v248, s67, v1
v_accvgpr_write_b32 a170, v248
s_lshl_b32 s65, s62, 8
s_add_u32 s65, s65, 32896
s_lshl_b32 s66, s63, 2
s_add_u32 s66, s66, s65
v_mov_b32 v248, s66
v_accvgpr_write_b32 a141, v248
v_lshlrev_b32 v248, 2, v2
v_add_u32 v248, s65, v248
v_accvgpr_write_b32 a142, v248
v_and_b32 v250, 7, v0
v_lshlrev_b32 v250, 2, v250
v_lshlrev_b32 v251, 4, v3
s_lshl_b32 s62, s59, 14
s_lshl_b32 s63, s50, 11
s_add_u32 s65, s62, s63
s_add_u32 s65, s65, 4194304
v_add_u32_e64 v248, s65, v1
v_accvgpr_write_b32 a143, v248
s_lshl_b32 s64, s59, 8
s_add_u32 s64, s64, 32768
s_lshl_b32 s65, s50, 2
s_add_u32 s65, s65, s64
v_mov_b32 v248, s65
v_accvgpr_write_b32 a144, v248
v_add_u32_e64 v248, s64, v250
v_accvgpr_write_b32 a145, v248
s_lshl_b32 s65, s59, 12
s_add_u32 s65, s65, 1048576
v_lshlrev_b32 v249, 6, v2
v_add_u32 v249, s65, v249
v_add_u32 v248, v251, v249
v_accvgpr_write_b32 a147, v248
s_lshl_b32 s65, s50, 3
v_add_u32 v248, s65, v249
v_accvgpr_write_b32 a146, v248
s_add_u32 s65, s62, 2097152
v_add_u32_e64 v248, s65, v1
v_accvgpr_write_b32 a148, v248
s_add_u32 s65, s62, 4194304
v_add_u32_e64 v248, s65, v1
v_accvgpr_write_b32 a149, v248
s_mul_i32 s65, s59, 45056
s_add_u32 s65, s65, 6291456
v_add_u32_e64 v248, s65, v1
v_accvgpr_write_b32 a159, v248
v_accvgpr_write_b32 a158, v248
s_lshl_b32 s62, s59, 14
s_lshl_b32 s63, s50, 7
s_add_u32 s62, s62, s63
v_and_b32 v248, 1, v3
v_lshlrev_b32 v248, 5, v248
v_lshrrev_b32 v249, 1, v3
v_lshl_add_u32 v248, v249, 4, v248
v_lshl_add_u32 v248, v2, 10, v248
v_add_u32_e64 v248, s62, v248
v_accvgpr_write_b32 a160, v248
v_lshrrev_b32 v18, 3, v0
v_and_b32 v5, 6, v18
v_and_b32 v6, 7, v0
v_xor_b32 v6, v6, v5
v_mul_u32_u24 v4, 2752, v18
v_lshl_add_u32 v4, v6, 4, v4
s_lshl_b32 s62, s87, 1
s_mul_i32 s63, s52, 44032
s_add_u32 s62, s62, s63
v_add_u32_e64 v4, s62, v4
v_add_u32 v7, 20992, v4
v_cmp_gt_u32 vcc, s88, v6
v_mov_b32 v12, 0x40000000
s_nop 0
v_cndmask_b32 v5, v12, v4, vcc
v_cndmask_b32 v12, v12, v7, vcc
s_lshl_b32 s98, s52, 12
s_lshl_b32 s99, s59, 14
s_add_u32 s99, s99, 4194304
s_mul_i32 s19, s49, 11
s_add_u32 s89, s19, s52
s_lshr_b32 s62, s50, 2
s_add_u32 s62, s62, 1
s_bitcmp1_b32 s50, 1
s_cselect_b32 s63, -1, 1
s_mul_i32 s62, s62, s63
s_lshl_b32 s63, s59, 4
s_add_u32 s63, s63, s62
v_add_u32 v36, s63, v2
v_lshrrev_b32 v37, 4, v36
v_lshlrev_b32 v37, 14, v37
v_and_b32 v38, 15, v36
v_lshl_add_u32 v38, v3, 4, v38
v_lshlrev_b32 v38, 4, v38
v_add_u32 v37, v37, v38
s_lshl_b32 s63, s50, 11
s_add_u32 s64, s63, 2097152
v_add_u32 v37, s64, v37
s_lshl_b32 s64, s48, 8
v_subrev_u32 v36, s64, v36
v_cmp_lt_u32 vcc, 0xff, v36
v_mov_b32 v36, 0x40000000
s_nop 0
v_cndmask_b32 v37, v37, v36, vcc
s_mov_b64 s[68:69], vcc
v_accvgpr_write_b32 a150, v37
s_lshl_b32 s64, s48, 1
s_add_u32 s65, s64, 2
s_sub_u32 s64, s64, 1
s_cmp_gt_i32 s62, 0
s_cselect_b32 s64, s65, s64
s_lshl_b32 s65, s64, 14
s_add_u32 s65, s65, s63
s_add_u32 s65, s65, 1572864
v_add_u32 v36, s65, v38
v_accvgpr_write_b32 a151, v36
s_lshl_b32 s65, s64, 5
s_lshl_b32 s63, s50, 2
s_add_u32 s65, s65, s63
s_add_u32 s65, s65, 24576
v_mov_b32 v36, s65
s_cmp_lt_u32 s64, 16
s_cselect_b64 s[68:69], s[68:69], 0
v_accvgpr_write_b32 a152, v36
s_lshl_b32 s62, s59, 8
s_add_u32 s62, s62, 32800
v_and_b32 v38, 7, v0
v_lshlrev_b32 v38, 2, v38
v_add_u32 v39, s62, v38
s_and_b32 s63, s59, 15
s_sub_u32 s64, s62, 256
s_cmp_eq_u32 s63, 0
s_cselect_b32 s64, s62, s64
s_add_u32 s66, s62, 256
s_cmp_eq_u32 s63, 15
s_cselect_b32 s66, s62, s66
s_cselect_b32 s93, 1, 0
s_branch Lpg_3_n
.p2align 12
Lpg_3:
s_setpc_b64 s[100:101]
s_nop 0
Lpg_3_n:
v_lshrrev_b32_e64 v36, 3, v0
v_bfe_u32 v37, v0, 1, 1
v_lshl_or_b32 v36, v36, 1, v37
v_add_u32 v37, s64, v38
v_cmp_eq_u32 vcc, 2, v36
s_nop 1
v_cndmask_b32 v39, v39, v37, vcc
v_add_u32 v37, s66, v38
v_cmp_eq_u32 vcc, 5, v36
s_nop 1
v_cndmask_b32 v39, v39, v37, vcc
v_accvgpr_write_b32 a153, v39
s_lshl_b32 s70, s48, 6
s_add_u32 s70, s70, 24576
s_lshl_b32 s64, s93, 5
s_add_u32 s70, s70, s64
s_cmp_eq_u32 s63, 0
s_cselect_b32 s71, 1, 0
s_cmp_eq_u32 s63, 15
s_cselect_b32 s71, 2, s71
s_cmp_eq_u32 s59, 0
s_cselect_b32 s71, 0, s71
s_cmp_eq_u32 s59, 127
s_cselect_b32 s71, 0, s71
s_lshl_b32 s64, s48, 15
s_add_u32 s64, s64, 1572864
s_add_u32 s65, s64, 16384
s_cmp_eq_u32 s59, 0
s_cselect_b32 s64, 0x40000000, s64
s_cmp_eq_u32 s59, 127
s_cselect_b32 s65, 0x40000000, s65
s_lshl_b32 s62, s59, 14
s_add_u32 s62, s62, 2097152
v_add_u32 v36, s62, v1
v_add_u32 v37, s64, v1
v_add_u32 v38, s65, v1
s_cmp_eq_u32 s63, 0
s_cselect_b32 s66, 1, 0
s_mov_b32 s67, s93
s_mul_i32 s62, s66, 1
v_cmp_gt_u32 vcc, s62, v2
s_nop 1
v_cndmask_b32 v248, v36, v37, vcc
s_mul_i32 s62, s67, 1
s_sub_u32 s62, 15, s62
v_cmp_lt_u32 vcc, s62, v2
s_nop 1
v_cndmask_b32 v249, v36, v38, vcc
v_add_u32 v249, 4096, v249
s_mul_i32 s62, s66, 2
v_cmp_gt_u32 vcc, s62, v2
s_nop 1
v_cndmask_b32 v250, v36, v37, vcc
v_add_u32 v250, 8192, v250
s_mul_i32 s62, s67, 2
s_sub_u32 s62, 15, s62
v_cmp_lt_u32 vcc, s62, v2
s_nop 1
v_cndmask_b32_e64 v251, v36, v38, vcc
v_add_u32 v251, 12288, v251
s_cmp_eq_u32 s93, 1
s_cselect_b64 s[72:73], -1, 0
v_cndmask_b32 v39, v249, v248, s[72:73]
v_accvgpr_write_b32 a154, v39
v_cndmask_b32 v39, v251, v250, s[72:73]
v_accvgpr_write_b32 a155, v39
v_cndmask_b32 v39, v248, v249, s[72:73]
v_accvgpr_write_b32 a156, v39
v_cndmask_b32 v39, v250, v251, s[72:73]
v_accvgpr_write_b32 a157, v39
v_accvgpr_read_b32 v248, a137
v_accvgpr_read_b32 v249, a138
v_accvgpr_read_b32 v250, a139
v_accvgpr_read_b32 v253, a140
v_accvgpr_read_b32 v254, a141
v_accvgpr_read_b32 v152, a170
s_lshl_b32 s62, s52, 10
v_add_u32 v251, s62, v1
v_add_u32 v251, 155648, v251
s_lshl_b32 s62, s54, 11
v_add_u32 v252, s62, v1
v_add_u32 v252, 155648, v252
s_lshl_b32 s62, s52, 6
v_add_u32 v150, s62, v1
v_add_u32 v150, 159744, v150
s_lshl_b32 s62, s54, 7
v_lshlrev_b32 v151, 4, v3
v_add_u32_e64 v151, s62, v151
v_add_u32 v151, 159744, v151
s_movk_i32 s61, 1
s_cmp_lg_u32 s57, 0
s_cbranch_scc1 Lpoll_18
s_mov_b32 s61, 0x8000
Lpoll_18:
buffer_load_dword v161, v248, s[44:47], 0 offen offset:0 sc1
s_waitcnt vmcnt(0)
v_cmp_ne_u32 vcc, s55, v161
s_cbranch_vccz Lpd_19
s_sub_u32 s61, s61, 1
s_cmp_lg_u32 s61, 0
s_cbranch_scc1 Lpoll_18
s_mov_b32 s57, 1
Lpd_19:
buffer_load_dwordx4 v[208:211], v250, s[44:47], 0 offen sc1
buffer_load_dwordx4 v[176:179], v249, s[44:47], 0 offen offset:0 sc1
buffer_load_dwordx4 v[180:183], v249, s[44:47], 0 offen offset:1024 sc1
buffer_load_dwordx4 v[184:187], v249, s[44:47], 0 offen offset:2048 sc1
buffer_load_dwordx4 v[188:191], v249, s[44:47], 0 offen offset:3072 sc1
buffer_load_dwordx4 v[192:195], v249, s[44:47], s4 offen offset:0 sc1
buffer_load_dwordx4 v[196:199], v249, s[44:47], s4 offen offset:1024 sc1
buffer_load_dwordx4 v[200:203], v249, s[44:47], s4 offen offset:2048 sc1
buffer_load_dwordx4 v[204:207], v249, s[44:47], s4 offen offset:3072 sc1
v_accvgpr_read_b32 v214, a168
v_accvgpr_read_b32 v215, a169
v_mov_b32 v212, 0
v_mov_b32 v213, 0
v_mov_b32 v216, 0
v_mov_b32 v217, 0
s_waitcnt vmcnt(8)
s_nop 0
v_mfma_f32_16x16x32_bf16 v[48:51], v[214:217], v[208:211], 0
v_mfma_f32_16x16x32_bf16 v[52:55], v[212:215], v[208:211], 0
s_waitcnt vmcnt(7)
v_mfma_f32_16x16x32_bf16 v[40:43], v[26:29], v[176:179], 0
v_mfma_f32_16x16x32_bf16 v[44:47], v[24:27], v[176:179], 0
s_waitcnt vmcnt(6)
v_mfma_f32_16x16x32_bf16 v[40:43], v[26:29], v[180:183], v[40:43]
v_mfma_f32_16x16x32_bf16 v[44:47], v[24:27], v[180:183], v[44:47]
s_nop 0
s_nop 0
v_add_f32_dpp v48, v48, v48 row_ror:4 row_mask:0xf bank_mask:0xf
v_add_f32_dpp v49, v49, v49 row_ror:4 row_mask:0xf bank_mask:0xf
v_add_f32_dpp v50, v50, v50 row_ror:4 row_mask:0xf bank_mask:0xf
v_add_f32_dpp v51, v51, v51 row_ror:4 row_mask:0xf bank_mask:0xf
v_add_f32_dpp v52, v52, v52 row_ror:4 row_mask:0xf bank_mask:0xf
v_add_f32_dpp v53, v53, v53 row_ror:4 row_mask:0xf bank_mask:0xf
v_add_f32_dpp v54, v54, v54 row_ror:4 row_mask:0xf bank_mask:0xf
v_add_f32_dpp v55, v55, v55 row_ror:4 row_mask:0xf bank_mask:0xf
s_waitcnt vmcnt(5)
v_mfma_f32_16x16x32_bf16 v[40:43], v[26:29], v[184:187], v[40:43]
v_mfma_f32_16x16x32_bf16 v[44:47], v[24:27], v[184:187], v[44:47]
s_waitcnt vmcnt(4)
v_mfma_f32_16x16x32_bf16 v[40:43], v[26:29], v[188:191], v[40:43]
v_mfma_f32_16x16x32_bf16 v[44:47], v[24:27], v[188:191], v[44:47]
v_add_f32_dpp v48, v48, v48 row_ror:8 row_mask:0xf bank_mask:0xf
v_add_f32_dpp v49, v49, v49 row_ror:8 row_mask:0xf bank_mask:0xf
v_add_f32_dpp v50, v50, v50 row_ror:8 row_mask:0xf bank_mask:0xf
v_add_f32_dpp v51, v51, v51 row_ror:8 row_mask:0xf bank_mask:0xf
v_add_f32_dpp v52, v52, v52 row_ror:8 row_mask:0xf bank_mask:0xf
v_add_f32_dpp v53, v53, v53 row_ror:8 row_mask:0xf bank_mask:0xf
v_add_f32_dpp v54, v54, v54 row_ror:8 row_mask:0xf bank_mask:0xf
v_add_f32_dpp v55, v55, v55 row_ror:8 row_mask:0xf bank_mask:0xf
s_waitcnt vmcnt(3)
v_mfma_f32_16x16x32_bf16 v[40:43], v[26:29], v[192:195], v[40:43]
v_mfma_f32_16x16x32_bf16 v[44:47], v[24:27], v[192:195], v[44:47]
s_waitcnt vmcnt(2)
v_mfma_f32_16x16x32_bf16 v[40:43], v[26:29], v[196:199], v[40:43]
v_mfma_f32_16x16x32_bf16 v[44:47], v[24:27], v[196:199], v[44:47]
v_cvt_pk_bf16_f32 v60, v48, v49
v_cvt_pk_bf16_f32 v61, v50, v51
v_cvt_pk_bf16_f32 v62, v52, v53
v_cvt_pk_bf16_f32 v63, v54, v55
s_waitcnt vmcnt(1)
v_mfma_f32_16x16x32_bf16 v[40:43], v[26:29], v[200:203], v[40:43]
v_mfma_f32_16x16x32_bf16 v[44:47], v[24:27], v[200:203], v[44:47]
s_waitcnt vmcnt(0)
v_mfma_f32_16x16x32_bf16 v[40:43], v[26:29], v[204:207], v[40:43]
v_mfma_f32_16x16x32_bf16 v[44:47], v[24:27], v[204:207], v[44:47]
s_nop 6
s_nop 0
v_cvt_pk_bf16_f32 v56, v40, v41
v_cvt_pk_bf16_f32 v57, v42, v43
v_cvt_pk_bf16_f32 v58, v44, v45
v_cvt_pk_bf16_f32 v59, v46, v47
ds_write_b128 v251, v[56:59]
s_mov_b64 exec, 15
ds_write_b128 v150, v[60:63]
s_mov_b64 exec, -1
s_waitcnt lgkmcnt(0)
s_barrier
ds_read_b128 v[40:43], v252 offset:0
ds_read_b128 v[44:47], v151 offset:0
ds_read_b128 v[48:51], v252 offset:1024
ds_read_b128 v[52:55], v151 offset:64
s_waitcnt lgkmcnt(0)
v_mfma_f32_16x16x32_bf16 v[176:179], v[40:43], v[128:131], 0
v_mfma_f32_16x16x32_bf16 v[180:183], v[44:47], v[128:131], 0
v_mfma_f32_16x16x32_bf16 v[184:187], v[48:51], v[136:139], 0
v_mfma_f32_16x16x32_bf16 v[188:191], v[52:55], v[136:139], 0
v_mfma_f32_16x16x32_bf16 v[192:195], v[40:43], v[132:135], 0
v_mfma_f32_16x16x32_bf16 v[196:199], v[44:47], v[132:135], 0
v_mfma_f32_16x16x32_bf16 v[200:203], v[48:51], v[140:143], 0
v_mfma_f32_16x16x32_bf16 v[204:207], v[52:55], v[140:143], 0
s_nop 1
v_add_f32 v180, 0x358637bd, v180
s_nop 0
v_add_f32 v188, 0x358637bd, v188
s_nop 0
v_add_f32 v196, 0x358637bd, v196
s_nop 0
v_add_f32 v204, 0x358637bd, v204
v_rcp_f32 v180, v180
v_rcp_f32 v188, v188
v_rcp_f32 v196, v196
v_rcp_f32 v204, v204
v_mov_b32 v181, v180
v_mov_b32 v189, v188
v_mov_b32 v197, v196
v_mov_b32_e64 v205, v204
v_pk_mul_f32 v[176:177], v[176:177], v[180:181]
v_pk_mul_f32 v[178:179], v[178:179], v[180:181]
v_pk_mul_f32 v[184:185], v[184:185], v[188:189]
v_pk_mul_f32 v[186:187], v[186:187], v[188:189]
v_pk_mul_f32 v[192:193], v[192:193], v[196:197]
v_pk_mul_f32 v[194:195], v[194:195], v[196:197]
v_pk_mul_f32 v[200:201], v[200:201], v[204:205]
v_pk_mul_f32 v[202:203], v[202:203], v[204:205]
v_cvt_pk_bf16_f32 v72, v176, v177
v_cvt_pk_bf16_f32 v73, v178, v179
v_cvt_pk_bf16_f32 v74, v184, v185
v_cvt_pk_bf16_f32 v75, v186, v187
v_cvt_pk_bf16_f32 v76, v192, v193
v_cvt_pk_bf16_f32 v77, v194, v195
v_cvt_pk_bf16_f32 v78, v200, v201
v_cvt_pk_bf16_f32 v79, v202, v203
s_cmp_eq_u32 s56, 0
s_cbranch_scc1 Lslow_20
buffer_store_dwordx4 v[72:75], v253, s[44:47], 0 offen
buffer_store_dwordx4 v[76:79], v152, s[44:47], 0 offen
s_branch Lpub_21
Lslow_20:
buffer_store_dwordx4 v[72:75], v253, s[44:47], 0 offen sc1
buffer_store_dwordx4 v[76:79], v152, s[44:47], 0 offen sc1
Lpub_21:
s_waitcnt vmcnt(0)
s_mov_b64 exec, 1
s_cmp_eq_u32 s56, 0
s_cbranch_scc1 Lslow_22
buffer_store_dword v9, v254, s[44:47], 0 offen offset:0
s_branch Lpub_23
Lslow_22:
buffer_store_dword v9, v254, s[44:47], 0 offen offset:0 sc1
Lpub_23:
s_mov_b64 exec, -1
s_add_u32 s0, s49, 0
s_and_b32 s0, s0, 3
s_lshl_b32 s1, s0, 15
s_add_u32 s1, s1, s97
s_lshl_b32 s0, s0, 12
s_add_u32 s0, s0, s96
s_add_u32 m0, s0, 65536
s_nop 0
buffer_load_dwordx4 v8, s[24:27], s1 offen offset:0 lds
buffer_load_dwordx4 v10, s[24:27], s1 offen offset:1024 lds
buffer_load_dwordx4 v11, s[24:27], s1 offen offset:2048 lds
buffer_load_dwordx4 v255, s[24:27], s1 offen offset:3072 lds
v_add_u32 v56, 0x10000, v14
v_add_u32 v57, 0x10000, v15
v_add_u32 v58, 0x10000, v16
v_add_u32 v59, 0x10000, v17
v_accvgpr_read_b32 v60, a143
v_accvgpr_read_b32 v61, a144
v_accvgpr_read_b32 v62, a145
v_accvgpr_read_b32 v63, a146
v_accvgpr_read_b32 v224, a147
ds_read_b64_tr_b16 v[128:129], v14 offset:0
ds_read_b64_tr_b16 v[130:131], v14 offset:2048
ds_read_b64_tr_b16 v[132:133], v15 offset:0
ds_read_b64_tr_b16 v[134:135], v15 offset:2048
ds_read_b64_tr_b16 v[136:137], v16 offset:0
ds_read_b64_tr_b16 v[138:139], v16 offset:2048
ds_read_b64_tr_b16 v[140:141], v17 offset:0
ds_read_b64_tr_b16 v[142:143], v17 offset:2048
ds_read_b64_tr_b16 v[144:145], v14 offset:4096
ds_read_b64_tr_b16 v[146:147], v14 offset:6144
ds_read_b64_tr_b16 v[148:149], v15 offset:4096
ds_read_b64_tr_b16 v[150:151], v15 offset:6144
ds_read_b64_tr_b16 v[152:153], v16 offset:4096
ds_read_b64_tr_b16 v[154:155], v16 offset:6144
ds_read_b64_tr_b16 v[156:157], v17 offset:4096
ds_read_b64_tr_b16 v[158:159], v17 offset:6144
ds_read_b64_tr_b16 v[160:161], v14 offset:8192
ds_read_b64_tr_b16 v[162:163], v14 offset:10240
ds_read_b64_tr_b16 v[164:165], v15 offset:8192
ds_read_b64_tr_b16 v[166:167], v15 offset:10240
ds_read_b64_tr_b16 v[168:169], v16 offset:8192
ds_read_b64_tr_b16 v[170:171], v16 offset:10240
ds_read_b64_tr_b16 v[172:173], v17 offset:8192
ds_read_b64_tr_b16 v[174:175], v17 offset:10240
v_lshlrev_b32_e64 v40, 16, v240
v_and_b32 v41, 0xffff0000, v240
v_lshlrev_b32_e64 v42, 16, v241
v_and_b32 v43, 0xffff0000, v241
v_lshlrev_b32_e64 v44, 16, v242
v_and_b32 v45, 0xffff0000, v242
v_lshlrev_b32_e64 v46, 16, v243
v_and_b32 v47, 0xffff0000, v243
v_lshlrev_b32_e64 v48, 16, v244
v_and_b32 v49, 0xffff0000, v244
v_lshlrev_b32_e64 v50, 16, v245
v_and_b32 v51, 0xffff0000, v245
v_lshlrev_b32_e64 v52, 16, v246
v_and_b32 v53, 0xffff0000, v246
v_lshlrev_b32_e64 v54, 16, v247
v_and_b32 v55, 0xffff0000, v247
v_accvgpr_read_b32 v184, a142
v_accvgpr_read_b32 v225, a148
s_movk_i32 s61, 1
s_cmp_lg_u32 s57, 0
s_cbranch_scc1 Lpoll_24
s_mov_b32 s61, 0x8000
Lpoll_24:
buffer_load_dword v185, v184, s[44:47], 0 offen offset:0 sc1
s_waitcnt vmcnt(0)
v_cmp_ne_u32 vcc, s55, v185
s_cbranch_vccz Lpd_25
s_sub_u32 s61, s61, 1
s_cmp_lg_u32 s61, 0
s_cbranch_scc1 Lpoll_24
s_mov_b32 s57, 1
Lpd_25:
buffer_load_dwordx4 v[64:67], v225, s[44:47], 0 offen offset:0 sc1
buffer_load_dwordx4 v[68:71], v225, s[44:47], 0 offen offset:1024 sc1
buffer_load_dwordx4 v[72:75], v225, s[44:47], 0 offen offset:2048 sc1
buffer_load_dwordx4 v[76:79], v225, s[44:47], 0 offen offset:3072 sc1
buffer_load_dwordx4 v[80:83], v225, s[44:47], s4 offen offset:0 sc1
buffer_load_dwordx4 v[84:87], v225, s[44:47], s4 offen offset:1024 sc1
s_waitcnt vmcnt(5) lgkmcnt(15)
v_mfma_f32_16x16x32_bf16 v[40:43], v[128:131], v[64:67], v[40:43]
s_nop 0
buffer_load_dwordx4 v[88:91], v225, s[44:47], s4 offen offset:2048 sc1
ds_read_b64_tr_b16 v[128:129], v14 offset:12288
ds_read_b64_tr_b16 v[130:131], v14 offset:14336
v_mfma_f32_16x16x32_bf16 v[44:47], v[132:135], v[64:67], v[44:47]
ds_read_b64_tr_b16 v[132:133], v15 offset:12288
ds_read_b64_tr_b16 v[134:135], v15 offset:14336
v_mfma_f32_16x16x32_bf16 v[48:51], v[136:139], v[64:67], v[48:51]
ds_read_b64_tr_b16 v[136:137], v16 offset:12288
ds_read_b64_tr_b16 v[138:139], v16 offset:14336
v_mfma_f32_16x16x32_bf16 v[52:55], v[140:143], v[64:67], v[52:55]
ds_read_b64_tr_b16 v[140:141], v17 offset:12288
ds_read_b64_tr_b16 v[142:143], v17 offset:14336
s_waitcnt vmcnt(5)
v_mfma_f32_16x16x32_bf16 v[40:43], v[144:147], v[68:71], v[40:43]
s_nop 0
buffer_load_dwordx4 v[92:95], v225, s[44:47], s4 offen offset:3072 sc1
ds_read_b64_tr_b16 v[144:145], v14 offset:16384
ds_read_b64_tr_b16 v[146:147], v14 offset:18432
v_mfma_f32_16x16x32_bf16 v[44:47], v[148:151], v[68:71], v[44:47]
ds_read_b64_tr_b16 v[148:149], v15 offset:16384
ds_read_b64_tr_b16 v[150:151], v15 offset:18432
v_mfma_f32_16x16x32_bf16 v[48:51], v[152:155], v[68:71], v[48:51]
ds_read_b64_tr_b16 v[152:153], v16 offset:16384
ds_read_b64_tr_b16 v[154:155], v16 offset:18432
v_mfma_f32_16x16x32_bf16 v[52:55], v[156:159], v[68:71], v[52:55]
ds_read_b64_tr_b16 v[156:157], v17 offset:16384
ds_read_b64_tr_b16 v[158:159], v17 offset:18432
s_waitcnt vmcnt(5) lgkmcnt(15)
v_mfma_f32_16x16x32_bf16 v[40:43], v[160:163], v[72:75], v[40:43]
s_nop 0
buffer_load_dwordx4 v[96:99], v225, s[44:47], s5 offen offset:0 sc1
ds_read_b64_tr_b16 v[160:161], v14 offset:20480
ds_read_b64_tr_b16 v[162:163], v14 offset:22528
v_mfma_f32_16x16x32_bf16 v[44:47], v[164:167], v[72:75], v[44:47]
ds_read_b64_tr_b16 v[164:165], v15 offset:20480
ds_read_b64_tr_b16 v[166:167], v15 offset:22528
v_mfma_f32_16x16x32_bf16 v[48:51], v[168:171], v[72:75], v[48:51]
ds_read_b64_tr_b16 v[168:169], v16 offset:20480
ds_read_b64_tr_b16 v[170:171], v16 offset:22528
v_mfma_f32_16x16x32_bf16 v[52:55], v[172:175], v[72:75], v[52:55]
ds_read_b64_tr_b16 v[172:173], v17 offset:20480
ds_read_b64_tr_b16 v[174:175], v17 offset:22528
s_waitcnt vmcnt(5)
v_mfma_f32_16x16x32_bf16 v[40:43], v[128:131], v[76:79], v[40:43]
s_nop 0
buffer_load_dwordx4 v[100:103], v225, s[44:47], s5 offen offset:1024 sc1
ds_read_b64_tr_b16 v[128:129], v14 offset:24576
ds_read_b64_tr_b16 v[130:131], v14 offset:26624
v_mfma_f32_16x16x32_bf16 v[44:47], v[132:135], v[76:79], v[44:47]
ds_read_b64_tr_b16 v[132:133], v15 offset:24576
ds_read_b64_tr_b16 v[134:135], v15 offset:26624
v_mfma_f32_16x16x32_bf16 v[48:51], v[136:139], v[76:79], v[48:51]
ds_read_b64_tr_b16 v[136:137], v16 offset:24576
ds_read_b64_tr_b16 v[138:139], v16 offset:26624
v_mfma_f32_16x16x32_bf16 v[52:55], v[140:143], v[76:79], v[52:55]
ds_read_b64_tr_b16 v[140:141], v17 offset:24576
ds_read_b64_tr_b16 v[142:143], v17 offset:26624
s_waitcnt vmcnt(5) lgkmcnt(15)
v_mfma_f32_16x16x32_bf16 v[40:43], v[144:147], v[80:83], v[40:43]
s_nop 0
buffer_load_dwordx4 v[104:107], v225, s[44:47], s5 offen offset:2048 sc1
ds_read_b64_tr_b16 v[144:145], v14 offset:28672
ds_read_b64_tr_b16 v[146:147], v14 offset:30720
v_mfma_f32_16x16x32_bf16 v[44:47], v[148:151], v[80:83], v[44:47]
ds_read_b64_tr_b16 v[148:149], v15 offset:28672
ds_read_b64_tr_b16 v[150:151], v15 offset:30720
v_mfma_f32_16x16x32_bf16 v[48:51], v[152:155], v[80:83], v[48:51]
ds_read_b64_tr_b16 v[152:153], v16 offset:28672
ds_read_b64_tr_b16 v[154:155], v16 offset:30720
v_mfma_f32_16x16x32_bf16 v[52:55], v[156:159], v[80:83], v[52:55]
ds_read_b64_tr_b16 v[156:157], v17 offset:28672
ds_read_b64_tr_b16 v[158:159], v17 offset:30720
s_waitcnt vmcnt(5)
v_mfma_f32_16x16x32_bf16 v[40:43], v[160:163], v[84:87], v[40:43]
s_nop 0
buffer_load_dwordx4 v[108:111], v225, s[44:47], s5 offen offset:3072 sc1
ds_read_b64_tr_b16 v[160:161], v14 offset:32768
ds_read_b64_tr_b16 v[162:163], v14 offset:34816
v_mfma_f32_16x16x32_bf16 v[44:47], v[164:167], v[84:87], v[44:47]
ds_read_b64_tr_b16 v[164:165], v15 offset:32768
ds_read_b64_tr_b16 v[166:167], v15 offset:34816
v_mfma_f32_16x16x32_bf16 v[48:51], v[168:171], v[84:87], v[48:51]
ds_read_b64_tr_b16 v[168:169], v16 offset:32768
ds_read_b64_tr_b16 v[170:171], v16 offset:34816
v_mfma_f32_16x16x32_bf16 v[52:55], v[172:175], v[84:87], v[52:55]
ds_read_b64_tr_b16 v[172:173], v17 offset:32768
ds_read_b64_tr_b16 v[174:175], v17 offset:34816
s_waitcnt vmcnt(5) lgkmcnt(15)
v_mfma_f32_16x16x32_bf16 v[40:43], v[128:131], v[88:91], v[40:43]
s_nop 0
buffer_load_dwordx4 v[112:115], v225, s[44:47], s6 offen offset:0 sc1
ds_read_b64_tr_b16 v[128:129], v14 offset:36864
ds_read_b64_tr_b16 v[130:131], v14 offset:38912
v_mfma_f32_16x16x32_bf16 v[44:47], v[132:135], v[88:91], v[44:47]
ds_read_b64_tr_b16 v[132:133], v15 offset:36864
ds_read_b64_tr_b16 v[134:135], v15 offset:38912
v_mfma_f32_16x16x32_bf16 v[48:51], v[136:139], v[88:91], v[48:51]
ds_read_b64_tr_b16 v[136:137], v16 offset:36864
ds_read_b64_tr_b16 v[138:139], v16 offset:38912
v_mfma_f32_16x16x32_bf16 v[52:55], v[140:143], v[88:91], v[52:55]
ds_read_b64_tr_b16 v[140:141], v17 offset:36864
ds_read_b64_tr_b16 v[142:143], v17 offset:38912
s_waitcnt vmcnt(5)
v_mfma_f32_16x16x32_bf16 v[40:43], v[144:147], v[92:95], v[40:43]
s_nop 0
buffer_load_dwordx4 v[116:119], v225, s[44:47], s6 offen offset:1024 sc1
ds_read_b64_tr_b16 v[144:145], v14 offset:40960
ds_read_b64_tr_b16 v[146:147], v14 offset:43008
v_mfma_f32_16x16x32_bf16 v[44:47], v[148:151], v[92:95], v[44:47]
ds_read_b64_tr_b16 v[148:149], v15 offset:40960
ds_read_b64_tr_b16 v[150:151], v15 offset:43008
v_mfma_f32_16x16x32_bf16 v[48:51], v[152:155], v[92:95], v[48:51]
ds_read_b64_tr_b16 v[152:153], v16 offset:40960
ds_read_b64_tr_b16 v[154:155], v16 offset:43008
v_mfma_f32_16x16x32_bf16 v[52:55], v[156:159], v[92:95], v[52:55]
ds_read_b64_tr_b16 v[156:157], v17 offset:40960
ds_read_b64_tr_b16 v[158:159], v17 offset:43008
s_waitcnt vmcnt(5) lgkmcnt(15)
v_mfma_f32_16x16x32_bf16 v[40:43], v[160:163], v[96:99], v[40:43]
s_nop 0
buffer_load_dwordx4 v[120:123], v225, s[44:47], s6 offen offset:2048 sc1
ds_read_b64_tr_b16 v[160:161], v14 offset:45056
ds_read_b64_tr_b16 v[162:163], v14 offset:47104
v_mfma_f32_16x16x32_bf16 v[44:47], v[164:167], v[96:99], v[44:47]
ds_read_b64_tr_b16 v[164:165], v15 offset:45056
ds_read_b64_tr_b16 v[166:167], v15 offset:47104
v_mfma_f32_16x16x32_bf16 v[48:51], v[168:171], v[96:99], v[48:51]
ds_read_b64_tr_b16 v[168:169], v16 offset:45056
ds_read_b64_tr_b16 v[170:171], v16 offset:47104
v_mfma_f32_16x16x32_bf16 v[52:55], v[172:175], v[96:99], v[52:55]
ds_read_b64_tr_b16 v[172:173], v17 offset:45056
ds_read_b64_tr_b16 v[174:175], v17 offset:47104
s_waitcnt vmcnt(5)
v_mfma_f32_16x16x32_bf16 v[40:43], v[128:131], v[100:103], v[40:43]
s_nop 0
buffer_load_dwordx4 v[124:127], v225, s[44:47], s6 offen offset:3072 sc1
ds_read_b64_tr_b16 v[128:129], v14 offset:49152
ds_read_b64_tr_b16 v[130:131], v14 offset:51200
v_mfma_f32_16x16x32_bf16 v[44:47], v[132:135], v[100:103], v[44:47]
ds_read_b64_tr_b16 v[132:133], v15 offset:49152
ds_read_b64_tr_b16 v[134:135], v15 offset:51200
v_mfma_f32_16x16x32_bf16 v[48:51], v[136:139], v[100:103], v[48:51]
ds_read_b64_tr_b16 v[136:137], v16 offset:49152
ds_read_b64_tr_b16 v[138:139], v16 offset:51200
v_mfma_f32_16x16x32_bf16 v[52:55], v[140:143], v[100:103], v[52:55]
ds_read_b64_tr_b16 v[140:141], v17 offset:49152
ds_read_b64_tr_b16 v[142:143], v17 offset:51200
s_waitcnt vmcnt(5) lgkmcnt(15)
v_mfma_f32_16x16x32_bf16 v[40:43], v[144:147], v[104:107], v[40:43]
s_add_u32 s0, s49, 1
ds_read_b64_tr_b16 v[144:145], v14 offset:53248
ds_read_b64_tr_b16 v[146:147], v14 offset:55296
v_mfma_f32_16x16x32_bf16 v[44:47], v[148:151], v[104:107], v[44:47]
s_and_b32 s0, s0, 3
s_lshl_b32 s1, s0, 15
ds_read_b64_tr_b16 v[148:149], v15 offset:53248
ds_read_b64_tr_b16 v[150:151], v15 offset:55296
v_mfma_f32_16x16x32_bf16 v[48:51], v[152:155], v[104:107], v[48:51]
s_add_u32 s1, s1, s97
ds_read_b64_tr_b16 v[152:153], v16 offset:53248
ds_read_b64_tr_b16 v[154:155], v16 offset:55296
v_mfma_f32_16x16x32_bf16 v[52:55], v[156:159], v[104:107], v[52:55]
s_lshl_b32 s0, s0, 12
s_add_u32 s0, s0, s96
ds_read_b64_tr_b16 v[156:157], v17 offset:53248
ds_read_b64_tr_b16 v[158:159], v17 offset:55296
s_waitcnt vmcnt(4)
v_mfma_f32_16x16x32_bf16 v[40:43], v[160:163], v[108:111], v[40:43]
s_add_u32 m0, s0, 65536
ds_read_b64_tr_b16 v[160:161], v14 offset:57344
ds_read_b64_tr_b16 v[162:163], v14 offset:59392
v_mfma_f32_16x16x32_bf16 v[44:47], v[164:167], v[108:111], v[44:47]
buffer_load_dwordx4 v8, s[24:27], s1 offen offset:0 lds
buffer_load_dwordx4 v10, s[24:27], s1 offen offset:1024 lds
ds_read_b64_tr_b16 v[164:165], v15 offset:57344
ds_read_b64_tr_b16 v[166:167], v15 offset:59392
v_mfma_f32_16x16x32_bf16 v[48:51], v[168:171], v[108:111], v[48:51]
buffer_load_dwordx4 v11, s[24:27], s1 offen offset:2048 lds
ds_read_b64_tr_b16 v[168:169], v16 offset:57344
ds_read_b64_tr_b16 v[170:171], v16 offset:59392
v_mfma_f32_16x16x32_bf16 v[52:55], v[172:175], v[108:111], v[52:55]
buffer_load_dwordx4 v255, s[24:27], s1 offen offset:3072 lds
s_add_u32 s0, s49, 2
ds_read_b64_tr_b16 v[172:173], v17 offset:57344
ds_read_b64_tr_b16 v[174:175], v17 offset:59392
s_waitcnt vmcnt(7) lgkmcnt(15)
v_mfma_f32_16x16x32_bf16 v[40:43], v[128:131], v[112:115], v[40:43]
s_and_b32 s0, s0, 3
ds_read_b64_tr_b16 v[128:129], v14 offset:61440
ds_read_b64_tr_b16 v[130:131], v14 offset:63488
v_mfma_f32_16x16x32_bf16 v[44:47], v[132:135], v[112:115], v[44:47]
s_lshl_b32 s1, s0, 15
s_add_u32 s1, s1, s97
ds_read_b64_tr_b16 v[132:133], v15 offset:61440
ds_read_b64_tr_b16 v[134:135], v15 offset:63488
v_mfma_f32_16x16x32_bf16 v[48:51], v[136:139], v[112:115], v[48:51]
s_lshl_b32 s0, s0, 12
ds_read_b64_tr_b16 v[136:137], v16 offset:61440
ds_read_b64_tr_b16 v[138:139], v16 offset:63488
v_mfma_f32_16x16x32_bf16 v[52:55], v[140:143], v[112:115], v[52:55]
s_add_u32 s0, s0, s96
s_nop 0
s_add_u32 m0, s0, 65536
ds_read_b64_tr_b16 v[140:141], v17 offset:61440
ds_read_b64_tr_b16 v[142:143], v17 offset:63488
s_waitcnt vmcnt(6)
v_mfma_f32_16x16x32_bf16 v[40:43], v[144:147], v[116:119], v[40:43]
buffer_load_dwordx4 v8, s[24:27], s1 offen offset:0 lds
v_mfma_f32_16x16x32_bf16 v[44:47], v[148:151], v[116:119], v[44:47]
buffer_load_dwordx4 v10, s[24:27], s1 offen offset:1024 lds
buffer_load_dwordx4 v11, s[24:27], s1 offen offset:2048 lds
v_mfma_f32_16x16x32_bf16 v[48:51], v[152:155], v[116:119], v[48:51]
buffer_load_dwordx4 v255, s[24:27], s1 offen offset:3072 lds
v_mfma_f32_16x16x32_bf16 v[52:55], v[156:159], v[116:119], v[52:55]
s_add_u32 s0, s49, 3
s_and_b32 s0, s0, 3
s_waitcnt vmcnt(9) lgkmcnt(8)
v_mfma_f32_16x16x32_bf16 v[40:43], v[160:163], v[120:123], v[40:43]
s_lshl_b32 s1, s0, 15
v_mfma_f32_16x16x32_bf16 v[44:47], v[164:167], v[120:123], v[44:47]
s_add_u32 s1, s1, s97
s_lshl_b32 s0, s0, 12
v_mfma_f32_16x16x32_bf16 v[48:51], v[168:171], v[120:123], v[48:51]
s_add_u32 s0, s0, s96
v_mfma_f32_16x16x32_bf16 v[52:55], v[172:175], v[120:123], v[52:55]
s_add_u32 m0, s0, 65536
s_nop 0
buffer_load_dwordx4 v8, s[24:27], s1 offen offset:0 lds
s_waitcnt vmcnt(9) lgkmcnt(0)
v_mfma_f32_16x16x32_bf16 v[40:43], v[128:131], v[124:127], v[40:43]
buffer_load_dwordx4 v10, s[24:27], s1 offen offset:1024 lds
v_mfma_f32_16x16x32_bf16 v[44:47], v[132:135], v[124:127], v[44:47]
buffer_load_dwordx4 v11, s[24:27], s1 offen offset:2048 lds
buffer_load_dwordx4 v255, s[24:27], s1 offen offset:3072 lds
v_mfma_f32_16x16x32_bf16 v[48:51], v[136:139], v[124:127], v[48:51]
s_lshl_b32 s0, s49, 1
v_mfma_f32_16x16x32_bf16 v[52:55], v[140:143], v[124:127], v[52:55]
s_add_u32 s0, s0, 2
s_and_b32 s0, s0, 7
s_mul_i32 s1, s0, 176128
s_add_u32 m0, s60, 131072
s_nop 0
buffer_load_dwordx4 v4, s[32:35], s1 offen offset:0 lds
buffer_load_dwordx4 v7, s[32:35], s1 offen offset:1024 lds
s_add_u32 m0, s60, 139264
s_add_u32 s3, s1, 128
buffer_load_dwordx4 v4, s[32:35], s3 offen offset:0 lds
buffer_load_dwordx4 v7, s[32:35], s3 offen offset:1024 lds
s_add_u32 m0, s60, 147456
s_add_u32 s3, s1, 256
buffer_load_dwordx4 v5, s[32:35], s3 offen offset:0 lds
buffer_load_dwordx4 v12, s[32:35], s3 offen offset:1024 lds
v_cvt_pk_bf16_f32 v232, v40, v41
v_cvt_pk_bf16_f32 v233, v42, v43
v_cvt_pk_bf16_f32 v234, v44, v45
v_cvt_pk_bf16_f32 v235, v46, v47
v_cvt_pk_bf16_f32 v236, v48, v49
v_cvt_pk_bf16_f32 v237, v50, v51
v_cvt_pk_bf16_f32 v238, v52, v53
v_cvt_pk_bf16_f32 v239, v54, v55
s_cmp_eq_u32 s56, 0
s_cbranch_scc1 Lslow_26
buffer_store_dwordx4 v[232:235], v60, s[44:47], 0 offen
buffer_store_dwordx4 v[236:239], v60, s[44:47], 0 offen offset:1024
s_branch Lpub_27
Lslow_26:
s_nop 0
buffer_store_dwordx4 v[232:235], v60, s[44:47], 0 offen sc1
buffer_store_dwordx4 v[236:239], v60, s[44:47], 0 offen offset:1024 sc1
Lpub_27:
v_pk_add_f32 v[180:181], v[40:41], v[42:43]
v_pk_mul_f32 v[182:183], v[40:41], v[40:41]
v_pk_add_f32 v[184:185], v[44:45], v[46:47]
v_pk_mul_f32 v[186:187], v[44:45], v[44:45]
v_pk_fma_f32 v[182:183], v[42:43], v[42:43], v[182:183]
v_pk_fma_f32 v[186:187], v[46:47], v[46:47], v[186:187]
v_pk_add_f32 v[180:181], v[180:181], v[48:49]
v_pk_add_f32 v[184:185], v[184:185], v[50:51]
v_pk_fma_f32 v[182:183], v[48:49], v[48:49], v[182:183]
s_branch Lpg_4_n
.p2align 12
Lpg_4:
s_setpc_b64 s[100:101]
s_nop 0
Lpg_4_n:
v_pk_fma_f32 v[186:187], v[50:51], v[50:51], v[186:187]
v_pk_add_f32 v[180:181], v[180:181], v[52:53]
v_pk_add_f32 v[184:185], v[184:185], v[54:55]
v_pk_fma_f32 v[182:183], v[52:53], v[52:53], v[182:183]
v_pk_fma_f32 v[186:187], v[54:55], v[54:55], v[186:187]
v_pk_add_f32 v[180:181], v[180:181], v[184:185]
v_pk_add_f32 v[182:183], v[182:183], v[186:187]
v_add_f32 v180, v180, v181
v_add_f32 v181, v182, v183
s_nop 1
v_permlane32_swap_b32 v180, v181
v_add_f32 v180, v180, v181
v_mov_b32 v181, v180
s_nop 1
v_permlane16_swap_b32 v180, v181
v_add_f32 v180, v180, v181
v_mov_b32 v181, v180
s_nop 1
v_permlane32_swap_b32 v180, v181
s_mov_b64 exec, 0xffff
s_cmp_eq_u32 s56, 0
s_cbranch_scc1 Lslow_28
buffer_store_dwordx2 v[180:181], v63, s[44:47], 0 offen offset:0
s_branch Lpub_29
Lslow_28:
buffer_store_dwordx2 v[180:181], v63, s[44:47], 0 offen offset:0 sc1
Lpub_29:
s_mov_b64 exec, -1
s_waitcnt vmcnt(0)
s_mov_b64 exec, 1
s_cmp_eq_u32 s56, 0
s_cbranch_scc1 Lslow_30
buffer_store_dword v9, v61, s[44:47], 0 offen offset:0
s_branch Lpub_31
Lslow_30:
buffer_store_dword v9, v61, s[44:47], 0 offen offset:0 sc1
Lpub_31:
s_mov_b64 exec, -1
s_or_b32 s62, s2, s52
s_cmp_eq_u32 s62, 0
s_cselect_b32 s62, 0, 0x40000000
s_mov_b64 exec, 1
buffer_store_dword v9, off, s[44:47], s62 sc1
s_mov_b64 exec, -1
s_barrier
s_add_u32 s0, s49, 0
s_and_b32 s0, s0, 3
s_lshl_b32 s1, s0, 15
s_add_u32 s1, s1, s97
s_lshl_b32 s0, s0, 12
s_add_u32 s0, s0, s96
s_add_u32 m0, s0, 0
s_nop 0
buffer_load_dwordx4 v8, s[28:31], s1 offen offset:0 lds
buffer_load_dwordx4 v10, s[28:31], s1 offen offset:1024 lds
buffer_load_dwordx4 v11, s[28:31], s1 offen offset:2048 lds
buffer_load_dwordx4 v255, s[28:31], s1 offen offset:3072 lds
s_lshl_b32 s62, s52, 5
v_xor_b32 v184, s62, v56
ds_read_b64_tr_b16 v[64:65], v184 offset:0
ds_read_b64_tr_b16 v[66:67], v184 offset:2048
ds_read_b64_tr_b16 v[68:69], v184 offset:4096
ds_read_b64_tr_b16 v[70:71], v184 offset:6144
ds_read_b64_tr_b16 v[72:73], v184 offset:8192
ds_read_b64_tr_b16 v[74:75], v184 offset:10240
ds_read_b64_tr_b16 v[76:77], v184 offset:12288
ds_read_b64_tr_b16 v[78:79], v184 offset:14336
ds_read_b64_tr_b16 v[80:81], v184 offset:16384
ds_read_b64_tr_b16 v[82:83], v184 offset:18432
ds_read_b64_tr_b16 v[84:85], v184 offset:20480
ds_read_b64_tr_b16 v[86:87], v184 offset:22528
ds_read_b64_tr_b16 v[88:89], v184 offset:24576
ds_read_b64_tr_b16 v[90:91], v184 offset:26624
ds_read_b64_tr_b16 v[92:93], v184 offset:28672
ds_read_b64_tr_b16 v[94:95], v184 offset:30720
ds_read_b64_tr_b16 v[96:97], v184 offset:32768
ds_read_b64_tr_b16 v[98:99], v184 offset:34816
ds_read_b64_tr_b16 v[100:101], v184 offset:36864
ds_read_b64_tr_b16 v[102:103], v184 offset:38912
ds_read_b64_tr_b16 v[104:105], v184 offset:40960
ds_read_b64_tr_b16 v[106:107], v184 offset:43008
ds_read_b64_tr_b16 v[108:109], v184 offset:45056
ds_read_b64_tr_b16 v[110:111], v184 offset:47104
ds_read_b64_tr_b16 v[112:113], v184 offset:49152
ds_read_b64_tr_b16 v[114:115], v184 offset:51200
ds_read_b64_tr_b16 v[116:117], v184 offset:53248
ds_read_b64_tr_b16 v[118:119], v184 offset:55296
ds_read_b64_tr_b16 v[120:121], v184 offset:57344
ds_read_b64_tr_b16 v[122:123], v184 offset:59392
ds_read_b64_tr_b16 v[124:125], v184 offset:61440
ds_read_b64_tr_b16 v[126:127], v184 offset:63488
s_lshl_b32 s62, s52, 6
v_lshlrev_b32 v185, 4, v3
v_add_u32 v185, 157696, v185
v_add_u32 v186, s62, v185
s_waitcnt lgkmcnt(15)
v_mfma_f32_16x16x32_bf16 v[188:191], v[64:67], v[20:23], 0
v_mfma_f32_16x16x32_bf16 v[180:183], v[68:71], v[20:23], 0
v_mfma_f32_16x16x32_bf16 v[188:191], v[72:75], v[20:23], v[188:191]
v_mfma_f32_16x16x32_bf16 v[180:183], v[76:79], v[20:23], v[180:183]
v_mfma_f32_16x16x32_bf16 v[188:191], v[80:83], v[20:23], v[188:191]
v_mfma_f32_16x16x32_bf16 v[180:183], v[84:87], v[20:23], v[180:183]
v_mfma_f32_16x16x32_bf16 v[188:191], v[88:91], v[20:23], v[188:191]
v_mfma_f32_16x16x32_bf16 v[180:183], v[92:95], v[20:23], v[180:183]
s_waitcnt lgkmcnt(8)
v_mfma_f32_16x16x32_bf16 v[188:191], v[96:99], v[20:23], v[188:191]
v_mfma_f32_16x16x32_bf16 v[180:183], v[100:103], v[20:23], v[180:183]
v_mfma_f32_16x16x32_bf16 v[188:191], v[104:107], v[20:23], v[188:191]
v_mfma_f32_16x16x32_bf16 v[180:183], v[108:111], v[20:23], v[180:183]
s_waitcnt lgkmcnt(0)
v_mfma_f32_16x16x32_bf16 v[188:191], v[112:115], v[20:23], v[188:191]
v_mfma_f32_16x16x32_bf16 v[180:183], v[116:119], v[20:23], v[180:183]
v_mfma_f32_16x16x32_bf16 v[188:191], v[120:123], v[20:23], v[188:191]
v_mfma_f32_16x16x32_bf16 v[180:183], v[124:127], v[20:23], v[180:183]
s_nop 7
v_pk_add_f32 v[188:189], v[188:189], v[180:181]
v_pk_add_f32 v[190:191], v[190:191], v[182:183]
s_mov_b64 exec, s[76:77]
ds_write_b128 v186, v[188:191]
s_mov_b64 exec, -1
s_waitcnt lgkmcnt(0)
s_barrier
s_nop 0
ds_read_b128 v[208:211], v185 offset:0
ds_read_b128 v[212:215], v185 offset:64
ds_read_b128 v[216:219], v185 offset:128
ds_read_b128 v[220:223], v185 offset:192
v_accvgpr_read_b32 v225, a149
v_accvgpr_read_b32 v200, a150
v_accvgpr_read_b32 v201, a151
v_accvgpr_read_b32 v202, a152
s_movk_i32 s61, 1
s_cmp_lg_u32 s57, 0
s_cbranch_scc1 Lpoll_32
s_mov_b32 s61, 0x8000
Lpoll_32:
buffer_load_dword v185, v62, s[44:47], 0 offen offset:0 sc1
s_waitcnt vmcnt(0)
v_cmp_ne_u32 vcc, s55, v185
s_cbranch_vccz Lpd_33
s_sub_u32 s61, s61, 1
s_cmp_lg_u32 s61, 0
s_cbranch_scc1 Lpoll_32
s_mov_b32 s57, 1
Lpd_33:
buffer_load_dwordx4 v[188:191], v224, s[44:47], 0 offen offset:0 sc1
buffer_load_dwordx4 v[64:67], v225, s[44:47], 0 offen offset:0 sc1
buffer_load_dwordx4 v[68:71], v225, s[44:47], 0 offen offset:1024 sc1
buffer_load_dwordx4 v[72:75], v225, s[44:47], 0 offen offset:2048 sc1
buffer_load_dwordx4 v[76:79], v225, s[44:47], 0 offen offset:3072 sc1
buffer_load_dwordx4 v[80:83], v225, s[44:47], s4 offen offset:0 sc1
buffer_load_dwordx4 v[84:87], v225, s[44:47], s4 offen offset:1024 sc1
ds_read_b64_tr_b16 v[128:129], v56 offset:0
ds_read_b64_tr_b16 v[130:131], v56 offset:2048
ds_read_b64_tr_b16 v[132:133], v57 offset:0
ds_read_b64_tr_b16 v[134:135], v57 offset:2048
ds_read_b64_tr_b16 v[136:137], v58 offset:0
ds_read_b64_tr_b16 v[138:139], v58 offset:2048
ds_read_b64_tr_b16 v[140:141], v59 offset:0
ds_read_b64_tr_b16 v[142:143], v59 offset:2048
ds_read_b64_tr_b16 v[144:145], v56 offset:4096
ds_read_b64_tr_b16 v[146:147], v56 offset:6144
ds_read_b64_tr_b16 v[148:149], v57 offset:4096
ds_read_b64_tr_b16 v[150:151], v57 offset:6144
ds_read_b64_tr_b16 v[152:153], v58 offset:4096
ds_read_b64_tr_b16 v[154:155], v58 offset:6144
ds_read_b64_tr_b16 v[156:157], v59 offset:4096
ds_read_b64_tr_b16 v[158:159], v59 offset:6144
ds_read_b64_tr_b16 v[160:161], v56 offset:8192
ds_read_b64_tr_b16 v[162:163], v56 offset:10240
ds_read_b64_tr_b16 v[164:165], v57 offset:8192
ds_read_b64_tr_b16 v[166:167], v57 offset:10240
ds_read_b64_tr_b16 v[168:169], v58 offset:8192
ds_read_b64_tr_b16 v[170:171], v58 offset:10240
ds_read_b64_tr_b16 v[172:173], v59 offset:8192
ds_read_b64_tr_b16 v[174:175], v59 offset:10240
s_waitcnt vmcnt(5) lgkmcnt(15)
v_mfma_f32_16x16x32_bf16 v[40:43], v[128:131], v[64:67], 0
s_nop 0
buffer_load_dwordx4 v[88:91], v225, s[44:47], s4 offen offset:2048 sc1
ds_read_b64_tr_b16 v[128:129], v56 offset:12288
ds_read_b64_tr_b16 v[130:131], v56 offset:14336
v_mfma_f32_16x16x32_bf16 v[44:47], v[132:135], v[64:67], 0
ds_read_b64_tr_b16 v[132:133], v57 offset:12288
ds_read_b64_tr_b16 v[134:135], v57 offset:14336
v_mfma_f32_16x16x32_bf16 v[48:51], v[136:139], v[64:67], 0
ds_read_b64_tr_b16 v[136:137], v58 offset:12288
ds_read_b64_tr_b16 v[138:139], v58 offset:14336
v_mfma_f32_16x16x32_bf16 v[52:55], v[140:143], v[64:67], 0
ds_read_b64_tr_b16 v[140:141], v59 offset:12288
ds_read_b64_tr_b16 v[142:143], v59 offset:14336
s_waitcnt vmcnt(5)
v_mfma_f32_16x16x32_bf16 v[40:43], v[144:147], v[68:71], v[40:43]
s_nop 0
buffer_load_dwordx4 v[92:95], v225, s[44:47], s4 offen offset:3072 sc1
ds_read_b64_tr_b16 v[144:145], v56 offset:16384
ds_read_b64_tr_b16 v[146:147], v56 offset:18432
v_mfma_f32_16x16x32_bf16 v[44:47], v[148:151], v[68:71], v[44:47]
ds_read_b64_tr_b16 v[148:149], v57 offset:16384
ds_read_b64_tr_b16 v[150:151], v57 offset:18432
v_mfma_f32_16x16x32_bf16 v[48:51], v[152:155], v[68:71], v[48:51]
ds_read_b64_tr_b16 v[152:153], v58 offset:16384
ds_read_b64_tr_b16 v[154:155], v58 offset:18432
v_mfma_f32_16x16x32_bf16 v[52:55], v[156:159], v[68:71], v[52:55]
ds_read_b64_tr_b16 v[156:157], v59 offset:16384
ds_read_b64_tr_b16 v[158:159], v59 offset:18432
s_waitcnt vmcnt(5) lgkmcnt(15)
v_mfma_f32_16x16x32_bf16 v[40:43], v[160:163], v[72:75], v[40:43]
s_nop 0
buffer_load_dwordx4 v[96:99], v225, s[44:47], s5 offen offset:0 sc1
ds_read_b64_tr_b16 v[160:161], v56 offset:20480
ds_read_b64_tr_b16 v[162:163], v56 offset:22528
v_mfma_f32_16x16x32_bf16 v[44:47], v[164:167], v[72:75], v[44:47]
ds_read_b64_tr_b16 v[164:165], v57 offset:20480
ds_read_b64_tr_b16 v[166:167], v57 offset:22528
v_mfma_f32_16x16x32_bf16 v[48:51], v[168:171], v[72:75], v[48:51]
ds_read_b64_tr_b16 v[168:169], v58 offset:20480
ds_read_b64_tr_b16 v[170:171], v58 offset:22528
v_mfma_f32_16x16x32_bf16 v[52:55], v[172:175], v[72:75], v[52:55]
ds_read_b64_tr_b16 v[172:173], v59 offset:20480
ds_read_b64_tr_b16 v[174:175], v59 offset:22528
s_waitcnt vmcnt(5)
v_mfma_f32_16x16x32_bf16 v[40:43], v[128:131], v[76:79], v[40:43]
s_nop 0
buffer_load_dwordx4 v[100:103], v225, s[44:47], s5 offen offset:1024 sc1
ds_read_b64_tr_b16 v[128:129], v56 offset:24576
ds_read_b64_tr_b16 v[130:131], v56 offset:26624
v_mfma_f32_16x16x32_bf16 v[44:47], v[132:135], v[76:79], v[44:47]
ds_read_b64_tr_b16 v[132:133], v57 offset:24576
ds_read_b64_tr_b16 v[134:135], v57 offset:26624
v_mfma_f32_16x16x32_bf16 v[48:51], v[136:139], v[76:79], v[48:51]
ds_read_b64_tr_b16 v[136:137], v58 offset:24576
ds_read_b64_tr_b16 v[138:139], v58 offset:26624
v_mfma_f32_16x16x32_bf16 v[52:55], v[140:143], v[76:79], v[52:55]
ds_read_b64_tr_b16 v[140:141], v59 offset:24576
ds_read_b64_tr_b16 v[142:143], v59 offset:26624
s_waitcnt vmcnt(5) lgkmcnt(15)
v_mfma_f32_16x16x32_bf16 v[40:43], v[144:147], v[80:83], v[40:43]
s_nop 0
buffer_load_dwordx4 v[104:107], v225, s[44:47], s5 offen offset:2048 sc1
ds_read_b64_tr_b16 v[144:145], v56 offset:28672
ds_read_b64_tr_b16 v[146:147], v56 offset:30720
v_pk_add_f32 v[188:189], v[188:189], v[190:191]
v_mfma_f32_16x16x32_bf16 v[44:47], v[148:151], v[80:83], v[44:47]
ds_read_b64_tr_b16 v[148:149], v57 offset:28672
ds_read_b64_tr_b16 v[150:151], v57 offset:30720
v_permlane32_swap_b32 v188, v189
v_mfma_f32_16x16x32_bf16 v[48:51], v[152:155], v[80:83], v[48:51]
ds_read_b64_tr_b16 v[152:153], v58 offset:28672
ds_read_b64_tr_b16 v[154:155], v58 offset:30720
v_mfma_f32_16x16x32_bf16 v[52:55], v[156:159], v[80:83], v[52:55]
ds_read_b64_tr_b16 v[156:157], v59 offset:28672
ds_read_b64_tr_b16 v[158:159], v59 offset:30720
s_waitcnt vmcnt(5)
v_mfma_f32_16x16x32_bf16 v[40:43], v[160:163], v[84:87], v[40:43]
buffer_load_dwordx4 v[108:111], v225, s[44:47], s5 offen offset:3072 sc1
ds_read_b64_tr_b16 v[160:161], v56 offset:32768
ds_read_b64_tr_b16 v[162:163], v56 offset:34816
v_add_f32_e64 v188, v188, v189
v_mfma_f32_16x16x32_bf16 v[44:47], v[164:167], v[84:87], v[44:47]
ds_read_b64_tr_b16 v[164:165], v57 offset:32768
ds_read_b64_tr_b16 v[166:167], v57 offset:34816
v_mov_b32 v189, v188
s_nop 1
v_permlane16_swap_b32 v188, v189
v_mfma_f32_16x16x32_bf16 v[48:51], v[168:171], v[84:87], v[48:51]
ds_read_b64_tr_b16 v[168:169], v58 offset:32768
ds_read_b64_tr_b16 v[170:171], v58 offset:34816
v_mfma_f32_16x16x32_bf16 v[52:55], v[172:175], v[84:87], v[52:55]
ds_read_b64_tr_b16 v[172:173], v59 offset:32768
ds_read_b64_tr_b16 v[174:175], v59 offset:34816
s_waitcnt vmcnt(5) lgkmcnt(15)
v_mfma_f32_16x16x32_bf16 v[40:43], v[128:131], v[88:91], v[40:43]
buffer_load_dwordx4 v[112:115], v225, s[44:47], s6 offen offset:0 sc1
ds_read_b64_tr_b16 v[128:129], v56 offset:36864
ds_read_b64_tr_b16 v[130:131], v56 offset:38912
v_add_f32_e64 v188, v188, v189
v_mfma_f32_16x16x32_bf16 v[44:47], v[132:135], v[88:91], v[44:47]
ds_read_b64_tr_b16 v[132:133], v57 offset:36864
ds_read_b64_tr_b16 v[134:135], v57 offset:38912
v_mov_b32 v189, v188
s_nop 1
v_permlane32_swap_b32 v188, v189
v_mfma_f32_16x16x32_bf16 v[48:51], v[136:139], v[88:91], v[48:51]
ds_read_b64_tr_b16 v[136:137], v58 offset:36864
ds_read_b64_tr_b16 v[138:139], v58 offset:38912
v_mfma_f32_16x16x32_bf16 v[52:55], v[140:143], v[88:91], v[52:55]
ds_read_b64_tr_b16 v[140:141], v59 offset:36864
ds_read_b64_tr_b16 v[142:143], v59 offset:38912
s_waitcnt vmcnt(5)
v_mfma_f32_16x16x32_bf16 v[40:43], v[144:147], v[92:95], v[40:43]
buffer_load_dwordx4 v[116:119], v225, s[44:47], s6 offen offset:1024 sc1
ds_read_b64_tr_b16 v[144:145], v56 offset:40960
ds_read_b64_tr_b16 v[146:147], v56 offset:43008
v_mul_f32_e64 v230, s83, v188
v_mfma_f32_16x16x32_bf16 v[44:47], v[148:151], v[92:95], v[44:47]
ds_read_b64_tr_b16 v[148:149], v57 offset:40960
ds_read_b64_tr_b16 v[150:151], v57 offset:43008
v_mul_f32_e64 v189, s83, v189
v_fma_f32 v189, -v230, v230, v189
v_mfma_f32_16x16x32_bf16 v[48:51], v[152:155], v[92:95], v[48:51]
ds_read_b64_tr_b16 v[152:153], v58 offset:40960
ds_read_b64_tr_b16 v[154:155], v58 offset:43008
v_mfma_f32_16x16x32_bf16 v[52:55], v[156:159], v[92:95], v[52:55]
ds_read_b64_tr_b16 v[156:157], v59 offset:40960
ds_read_b64_tr_b16 v[158:159], v59 offset:43008
s_waitcnt vmcnt(5) lgkmcnt(15)
v_mfma_f32_16x16x32_bf16 v[40:43], v[160:163], v[96:99], v[40:43]
s_nop 0
buffer_load_dwordx4 v[120:123], v225, s[44:47], s6 offen offset:2048 sc1
ds_read_b64_tr_b16 v[160:161], v56 offset:45056
ds_read_b64_tr_b16 v[162:163], v56 offset:47104
v_max_f32_e64 v189, 0, v189
v_mfma_f32_16x16x32_bf16 v[44:47], v[164:167], v[96:99], v[44:47]
ds_read_b64_tr_b16 v[164:165], v57 offset:45056
ds_read_b64_tr_b16 v[166:167], v57 offset:47104
v_add_f32 v190, s82, v189
v_rsq_f32 v231, v190
v_mfma_f32_16x16x32_bf16 v[48:51], v[168:171], v[96:99], v[48:51]
ds_read_b64_tr_b16 v[168:169], v58 offset:45056
ds_read_b64_tr_b16 v[170:171], v58 offset:47104
v_mfma_f32_16x16x32_bf16 v[52:55], v[172:175], v[96:99], v[52:55]
ds_read_b64_tr_b16 v[172:173], v59 offset:45056
ds_read_b64_tr_b16 v[174:175], v59 offset:47104
s_waitcnt vmcnt(5)
v_mfma_f32_16x16x32_bf16 v[40:43], v[128:131], v[100:103], v[40:43]
s_nop 0
buffer_load_dwordx4 v[124:127], v225, s[44:47], s6 offen offset:3072 sc1
ds_read_b64_tr_b16 v[128:129], v56 offset:49152
ds_read_b64_tr_b16 v[130:131], v56 offset:51200
v_mul_f32_e64 v190, v231, v231
v_mfma_f32_16x16x32_bf16 v[44:47], v[132:135], v[100:103], v[44:47]
ds_read_b64_tr_b16 v[132:133], v57 offset:49152
ds_read_b64_tr_b16 v[134:135], v57 offset:51200
v_mul_f32 v190, v189, v190
v_add_f32 v190, s82, v190
v_mfma_f32_16x16x32_bf16 v[48:51], v[136:139], v[100:103], v[48:51]
ds_read_b64_tr_b16 v[136:137], v58 offset:49152
ds_read_b64_tr_b16 v[138:139], v58 offset:51200
v_mfma_f32_16x16x32_bf16 v[52:55], v[140:143], v[100:103], v[52:55]
ds_read_b64_tr_b16 v[140:141], v59 offset:49152
ds_read_b64_tr_b16 v[142:143], v59 offset:51200
s_waitcnt vmcnt(5) lgkmcnt(15)
v_mfma_f32_16x16x32_bf16 v[40:43], v[144:147], v[104:107], v[40:43]
s_add_u32 s0, s49, 1
ds_read_b64_tr_b16 v[144:145], v56 offset:53248
ds_read_b64_tr_b16 v[146:147], v56 offset:55296
v_rsq_f32_e64 v190, v190
v_mfma_f32_16x16x32_bf16 v[44:47], v[148:151], v[104:107], v[44:47]
s_and_b32 s0, s0, 3
s_lshl_b32 s1, s0, 15
ds_read_b64_tr_b16 v[148:149], v57 offset:53248
ds_read_b64_tr_b16 v[150:151], v57 offset:55296
v_mov_b32 v226, v230
v_mov_b32 v227, v230
v_mfma_f32_16x16x32_bf16 v[48:51], v[152:155], v[104:107], v[48:51]
s_add_u32 s1, s1, s97
ds_read_b64_tr_b16 v[152:153], v58 offset:53248
ds_read_b64_tr_b16 v[154:155], v58 offset:55296
v_mfma_f32_16x16x32_bf16 v[52:55], v[156:159], v[104:107], v[52:55]
s_lshl_b32 s0, s0, 12
s_add_u32 s0, s0, s96
ds_read_b64_tr_b16 v[156:157], v59 offset:53248
ds_read_b64_tr_b16 v[158:159], v59 offset:55296
s_waitcnt vmcnt(4)
v_mfma_f32_16x16x32_bf16 v[40:43], v[160:163], v[108:111], v[40:43]
s_add_u32 m0, s0, 0
ds_read_b64_tr_b16 v[160:161], v56 offset:57344
ds_read_b64_tr_b16 v[162:163], v56 offset:59392
v_mul_f32 v228, v231, v190
v_mfma_f32_16x16x32_bf16 v[44:47], v[164:167], v[108:111], v[44:47]
buffer_load_dwordx4 v8, s[28:31], s1 offen offset:0 lds
buffer_load_dwordx4 v10, s[28:31], s1 offen offset:1024 lds
ds_read_b64_tr_b16 v[164:165], v57 offset:57344
ds_read_b64_tr_b16 v[166:167], v57 offset:59392
v_mul_f32_e64 v229, v231, v190
v_mfma_f32_16x16x32_bf16 v[48:51], v[168:171], v[108:111], v[48:51]
buffer_load_dwordx4 v11, s[28:31], s1 offen offset:2048 lds
ds_read_b64_tr_b16 v[168:169], v58 offset:57344
ds_read_b64_tr_b16 v[170:171], v58 offset:59392
v_mfma_f32_16x16x32_bf16 v[52:55], v[172:175], v[108:111], v[52:55]
buffer_load_dwordx4 v255, s[28:31], s1 offen offset:3072 lds
s_add_u32 s0, s49, 2
ds_read_b64_tr_b16 v[172:173], v59 offset:57344
ds_read_b64_tr_b16 v[174:175], v59 offset:59392
s_waitcnt vmcnt(7) lgkmcnt(15)
v_mfma_f32_16x16x32_bf16 v[40:43], v[128:131], v[112:115], v[40:43]
s_and_b32 s0, s0, 3
ds_read_b64_tr_b16 v[128:129], v56 offset:61440
ds_read_b64_tr_b16 v[130:131], v56 offset:63488
v_mfma_f32_16x16x32_bf16 v[44:47], v[132:135], v[112:115], v[44:47]
s_lshl_b32 s1, s0, 15
s_add_u32 s1, s1, s97
ds_read_b64_tr_b16 v[132:133], v57 offset:61440
ds_read_b64_tr_b16 v[134:135], v57 offset:63488
v_mfma_f32_16x16x32_bf16 v[48:51], v[136:139], v[112:115], v[48:51]
s_lshl_b32 s0, s0, 12
ds_read_b64_tr_b16 v[136:137], v58 offset:61440
ds_read_b64_tr_b16 v[138:139], v58 offset:63488
v_mfma_f32_16x16x32_bf16 v[52:55], v[140:143], v[112:115], v[52:55]
s_add_u32 s0, s0, s96
s_add_u32 m0, s0, 0
ds_read_b64_tr_b16 v[140:141], v59 offset:61440
ds_read_b64_tr_b16 v[142:143], v59 offset:63488
s_waitcnt vmcnt(6)
v_mfma_f32_16x16x32_bf16 v[40:43], v[144:147], v[116:119], v[40:43]
buffer_load_dwordx4 v8, s[28:31], s1 offen offset:0 lds
v_mfma_f32_16x16x32_bf16 v[44:47], v[148:151], v[116:119], v[44:47]
buffer_load_dwordx4 v10, s[28:31], s1 offen offset:1024 lds
buffer_load_dwordx4 v11, s[28:31], s1 offen offset:2048 lds
v_mfma_f32_16x16x32_bf16 v[48:51], v[152:155], v[116:119], v[48:51]
buffer_load_dwordx4 v255, s[28:31], s1 offen offset:3072 lds
v_mfma_f32_16x16x32_bf16 v[52:55], v[156:159], v[116:119], v[52:55]
s_add_u32 s0, s49, 3
s_and_b32 s0, s0, 3
s_waitcnt vmcnt(9) lgkmcnt(8)
v_mfma_f32_16x16x32_bf16 v[40:43], v[160:163], v[120:123], v[40:43]
s_lshl_b32 s1, s0, 15
v_mfma_f32_16x16x32_bf16 v[44:47], v[164:167], v[120:123], v[44:47]
s_add_u32 s1, s1, s97
s_lshl_b32 s0, s0, 12
v_mfma_f32_16x16x32_bf16 v[48:51], v[168:171], v[120:123], v[48:51]
s_add_u32 s0, s0, s96
v_mfma_f32_16x16x32_bf16 v[52:55], v[172:175], v[120:123], v[52:55]
s_add_u32 m0, s0, 0
s_nop 0
buffer_load_dwordx4 v8, s[28:31], s1 offen offset:0 lds
s_waitcnt vmcnt(9) lgkmcnt(0)
v_mfma_f32_16x16x32_bf16 v[40:43], v[128:131], v[124:127], v[40:43]
buffer_load_dwordx4 v10, s[28:31], s1 offen offset:1024 lds
v_mfma_f32_16x16x32_bf16 v[44:47], v[132:135], v[124:127], v[44:47]
buffer_load_dwordx4 v11, s[28:31], s1 offen offset:2048 lds
buffer_load_dwordx4 v255, s[28:31], s1 offen offset:3072 lds
v_mfma_f32_16x16x32_bf16 v[48:51], v[136:139], v[124:127], v[48:51]
v_mfma_f32_16x16x32_bf16 v[52:55], v[140:143], v[124:127], v[52:55]
s_nop 1
v_pk_fma_f32 v[40:41], v[208:209], v[226:227], v[40:41] neg_lo:[1,0,0] neg_hi:[1,0,0]
v_pk_fma_f32 v[42:43], v[210:211], v[226:227], v[42:43] neg_lo:[1,0,0] neg_hi:[1,0,0]
v_pk_fma_f32 v[44:45], v[212:213], v[226:227], v[44:45] neg_lo:[1,0,0] neg_hi:[1,0,0]
v_pk_fma_f32 v[46:47], v[214:215], v[226:227], v[46:47] neg_lo:[1,0,0] neg_hi:[1,0,0]
s_nop 0
s_nop 0
v_pk_fma_f32 v[48:49], v[216:217], v[226:227], v[48:49] neg_lo:[1,0,0] neg_hi:[1,0,0]
v_pk_fma_f32 v[50:51], v[218:219], v[226:227], v[50:51] neg_lo:[1,0,0] neg_hi:[1,0,0]
v_pk_fma_f32 v[52:53], v[220:221], v[226:227], v[52:53] neg_lo:[1,0,0] neg_hi:[1,0,0]
v_pk_fma_f32 v[54:55], v[222:223], v[226:227], v[54:55] neg_lo:[1,0,0] neg_hi:[1,0,0]
v_pk_mul_f32 v[40:41], v[40:41], v[228:229]
v_pk_mul_f32 v[42:43], v[42:43], v[228:229]
v_pk_mul_f32 v[44:45], v[44:45], v[228:229]
v_pk_mul_f32 v[46:47], v[46:47], v[228:229]
v_pk_mul_f32 v[48:49], v[48:49], v[228:229]
v_pk_mul_f32 v[50:51], v[50:51], v[228:229]
v_pk_mul_f32 v[52:53], v[52:53], v[228:229]
v_pk_mul_f32 v[54:55], v[54:55], v[228:229]
v_pk_mul_f32 v[64:65], v[40:41], v[40:41]
v_pk_mul_f32 v[66:67], v[42:43], v[42:43]
v_pk_mul_f32 v[68:69], v[44:45], v[44:45]
v_pk_mul_f32 v[70:71], v[46:47], v[46:47]
v_pk_mul_f32 v[72:73], v[48:49], v[48:49]
v_pk_mul_f32 v[74:75], v[50:51], v[50:51]
v_pk_mul_f32 v[76:77], v[52:53], v[52:53]
v_pk_mul_f32 v[78:79], v[54:55], v[54:55]
v_pk_fma_f32 v[64:65], v[64:65], s[80:81], s[80:81] op_sel:[0,1,0] op_sel_hi:[1,1,0]
v_pk_fma_f32 v[66:67], v[66:67], s[80:81], s[80:81] op_sel:[0,1,0] op_sel_hi:[1,1,0]
v_pk_fma_f32 v[68:69], v[68:69], s[80:81], s[80:81] op_sel:[0,1,0] op_sel_hi:[1,1,0]
v_pk_fma_f32 v[70:71], v[70:71], s[80:81], s[80:81] op_sel:[0,1,0] op_sel_hi:[1,1,0]
v_pk_fma_f32 v[72:73], v[72:73], s[80:81], s[80:81] op_sel:[0,1,0] op_sel_hi:[1,1,0]
v_pk_fma_f32 v[74:75], v[74:75], s[80:81], s[80:81] op_sel:[0,1,0] op_sel_hi:[1,1,0]
v_pk_fma_f32 v[76:77], v[76:77], s[80:81], s[80:81] op_sel:[0,1,0] op_sel_hi:[1,1,0]
v_pk_fma_f32 v[78:79], v[78:79], s[80:81], s[80:81] op_sel:[0,1,0] op_sel_hi:[1,1,0]
v_pk_mul_f32 v[64:65], v[64:65], v[40:41]
v_pk_mul_f32 v[66:67], v[66:67], v[42:43]
v_pk_mul_f32 v[68:69], v[68:69], v[44:45]
v_pk_mul_f32 v[70:71], v[70:71], v[46:47]
v_pk_mul_f32 v[72:73], v[72:73], v[48:49]
v_pk_mul_f32 v[74:75], v[74:75], v[50:51]
v_pk_mul_f32 v[76:77], v[76:77], v[52:53]
v_pk_mul_f32 v[78:79], v[78:79], v[54:55]
v_exp_f32 v64, v64
v_exp_f32 v65, v65
v_exp_f32 v66, v66
v_exp_f32 v67, v67
v_exp_f32 v68, v68
v_exp_f32 v69, v69
v_exp_f32 v70, v70
v_exp_f32 v71, v71
v_exp_f32 v72, v72
v_exp_f32 v73, v73
v_exp_f32 v74, v74
v_exp_f32 v75, v75
v_exp_f32 v76, v76
v_exp_f32 v77, v77
v_exp_f32 v78, v78
v_exp_f32 v79, v79
v_pk_add_f32 v[64:65], v[64:65], s[94:95]
v_pk_add_f32 v[66:67], v[66:67], s[94:95]
v_pk_add_f32 v[68:69], v[68:69], s[94:95]
v_pk_add_f32 v[70:71], v[70:71], s[94:95]
v_pk_add_f32 v[72:73], v[72:73], s[94:95]
v_pk_add_f32 v[74:75], v[74:75], s[94:95]
v_pk_add_f32 v[76:77], v[76:77], s[94:95]
v_pk_add_f32 v[78:79], v[78:79], s[94:95]
v_rcp_f32 v64, v64
v_rcp_f32 v65, v65
v_rcp_f32 v66, v66
v_rcp_f32 v67, v67
v_rcp_f32 v68, v68
v_rcp_f32 v69, v69
v_rcp_f32 v70, v70
v_rcp_f32 v71, v71
v_rcp_f32 v72, v72
v_rcp_f32 v73, v73
v_rcp_f32 v74, v74
v_rcp_f32 v75, v75
v_rcp_f32 v76, v76
v_rcp_f32 v77, v77
v_rcp_f32 v78, v78
v_rcp_f32 v79, v79
v_pk_mul_f32 v[40:41], v[40:41], v[64:65]
v_pk_mul_f32 v[42:43], v[42:43], v[66:67]
v_pk_mul_f32 v[44:45], v[44:45], v[68:69]
v_pk_mul_f32 v[46:47], v[46:47], v[70:71]
v_pk_mul_f32 v[48:49], v[48:49], v[72:73]
v_pk_mul_f32 v[50:51], v[50:51], v[74:75]
v_pk_mul_f32 v[52:53], v[52:53], v[76:77]
v_pk_mul_f32 v[54:55], v[54:55], v[78:79]
v_cvt_pk_bf16_f32 v192, v40, v41
v_cvt_pk_bf16_f32 v193, v42, v43
v_cvt_pk_bf16_f32 v194, v44, v45
v_cvt_pk_bf16_f32 v195, v46, v47
v_cvt_pk_bf16_f32 v196, v48, v49
v_cvt_pk_bf16_f32 v197, v50, v51
v_cvt_pk_bf16_f32 v198, v52, v53
v_cvt_pk_bf16_f32 v199, v54, v55
s_cmp_eq_u32 s56, 0
s_cbranch_scc1 Lslow_34
buffer_store_dwordx4 v[192:195], v200, s[44:47], 0 offen
buffer_store_dwordx4 v[196:199], v200, s[44:47], 0 offen offset:1024
s_branch Lpub_35
Lslow_34:
buffer_store_dwordx4 v[192:195], v200, s[44:47], 0 offen sc1
buffer_store_dwordx4 v[196:199], v200, s[44:47], 0 offen offset:1024 sc1
Lpub_35:
s_waitcnt vmcnt(0)
s_mov_b64 exec, 1
s_cmp_eq_u32 s56, 0
s_cbranch_scc1 Lslow_36
buffer_store_dword v9, v61, s[44:47], 0 offen offset:32
s_branch Lpub_37
Lslow_36:
buffer_store_dword v9, v61, s[44:47], 0 offen offset:32 sc1
Lpub_37:
s_mov_b64 exec, -1
s_cmp_eq_u64 s[68:69], 0
s_cbranch_scc1 Lhalo_38
s_mov_b64 exec, s[68:69]
buffer_store_dwordx4 v[192:195], v201, s[44:47], 0 offen sc1
buffer_store_dwordx4 v[196:199], v201, s[44:47], 0 offen offset:1024 sc1
s_mov_b64 exec, -1
s_waitcnt vmcnt(0)
s_mov_b64 exec, 1
buffer_store_dword v9, v202, s[44:47], 0 offen offset:0 sc1
s_mov_b64 exec, -1
Lhalo_38:
s_barrier
s_lshl_b32 s0, s49, 1
s_add_u32 s0, s0, 0
s_and_b32 s0, s0, 7
s_mul_i32 s1, s0, 176128
s_add_u32 m0, s60, 65536
s_nop 0
s_nop 0
buffer_load_dwordx4 v4, s[32:35], s1 offen offset:0 lds
buffer_load_dwordx4 v7, s[32:35], s1 offen offset:1024 lds
s_add_u32 m0, s60, 73728
s_add_u32 s3, s1, 128
buffer_load_dwordx4 v4, s[32:35], s3 offen offset:0 lds
buffer_load_dwordx4 v7, s[32:35], s3 offen offset:1024 lds
s_add_u32 m0, s60, 81920
s_add_u32 s3, s1, 256
buffer_load_dwordx4 v5, s[32:35], s3 offen offset:0 lds
buffer_load_dwordx4 v12, s[32:35], s3 offen offset:1024 lds
s_cmp_eq_u32 s93, 1
s_cselect_b32 s62, 0, 1
s_lshl_b32 s62, s62, 14
v_add_u32 v192, s62, v14
v_add_u32 v193, s62, v15
v_add_u32 v194, s62, v16
v_add_u32 v195, s62, v17
s_cmp_eq_u32 s93, 1
s_cselect_b32 s62, 2, 3
s_lshl_b32 s62, s62, 14
v_add_u32 v196, s62, v14
v_add_u32 v197, s62, v15
v_add_u32 v198, s62, v16
v_add_u32 v199, s62, v17
s_cmp_eq_u32 s93, 1
s_cselect_b32 s62, 1, 0
s_lshl_b32 s62, s62, 14
v_add_u32 v200, s62, v14
v_add_u32 v201, s62, v15
v_add_u32 v202, s62, v16
v_add_u32 v203, s62, v17
s_cmp_eq_u32 s93, 1
s_cselect_b32 s62, 3, 2
s_lshl_b32 s62, s62, 14
v_add_u32 v204, s62, v14
v_add_u32 v205, s62, v15
v_add_u32 v206, s62, v16
v_add_u32 v207, s62, v17
ds_read_b64_tr_b16 v[128:129], v192 offset:0
ds_read_b64_tr_b16 v[130:131], v192 offset:2048
ds_read_b64_tr_b16 v[132:133], v193 offset:0
ds_read_b64_tr_b16 v[134:135], v193 offset:2048
ds_read_b64_tr_b16 v[136:137], v194 offset:0
ds_read_b64_tr_b16 v[138:139], v194 offset:2048
ds_read_b64_tr_b16 v[140:141], v195 offset:0
ds_read_b64_tr_b16 v[142:143], v195 offset:2048
ds_read_b64_tr_b16 v[144:145], v192 offset:4096
ds_read_b64_tr_b16 v[146:147], v192 offset:6144
ds_read_b64_tr_b16 v[148:149], v193 offset:4096
ds_read_b64_tr_b16 v[150:151], v193 offset:6144
s_branch Lpg_5_n
.p2align 12
Lpg_5:
s_setpc_b64 s[100:101]
s_nop 0
Lpg_5_n:
ds_read_b64_tr_b16 v[152:153], v194 offset:4096
ds_read_b64_tr_b16 v[154:155], v194 offset:6144
ds_read_b64_tr_b16 v[156:157], v195 offset:4096
ds_read_b64_tr_b16 v[158:159], v195 offset:6144
ds_read_b64_tr_b16 v[160:161], v192 offset:8192
ds_read_b64_tr_b16 v[162:163], v192 offset:10240
ds_read_b64_tr_b16 v[164:165], v193 offset:8192
ds_read_b64_tr_b16 v[166:167], v193 offset:10240
ds_read_b64_tr_b16 v[168:169], v194 offset:8192
ds_read_b64_tr_b16 v[170:171], v194 offset:10240
ds_read_b64_tr_b16 v[172:173], v195 offset:8192
ds_read_b64_tr_b16 v[174:175], v195 offset:10240
v_lshlrev_b32_e64 v40, 16, v232
v_and_b32 v41, 0xffff0000, v232
v_lshlrev_b32_e64 v42, 16, v233
v_and_b32 v43, 0xffff0000, v233
v_lshlrev_b32_e64 v44, 16, v234
v_and_b32 v45, 0xffff0000, v234
v_lshlrev_b32_e64 v46, 16, v235
v_and_b32 v47, 0xffff0000, v235
v_lshlrev_b32_e64 v48, 16, v236
v_and_b32 v49, 0xffff0000, v236
v_lshlrev_b32_e64 v50, 16, v237
v_and_b32 v51, 0xffff0000, v237
v_lshlrev_b32_e64 v52, 16, v238
v_and_b32 v53, 0xffff0000, v238
v_lshlrev_b32_e64 v54, 16, v239
v_and_b32 v55, 0xffff0000, v239
v_mul_f32 v228, v230, v231
v_mul_f32 v229, v230, v231
v_mov_b32 v226, v231
v_mov_b32 v227, v231
v_pk_fma_f32 v[40:41], v[40:41], v[226:227], v[228:229] neg_lo:[0,0,1] neg_hi:[0,0,1]
v_pk_fma_f32 v[42:43], v[42:43], v[226:227], v[228:229] neg_lo:[0,0,1] neg_hi:[0,0,1]
v_pk_fma_f32 v[44:45], v[44:45], v[226:227], v[228:229] neg_lo:[0,0,1] neg_hi:[0,0,1]
v_pk_fma_f32 v[46:47], v[46:47], v[226:227], v[228:229] neg_lo:[0,0,1] neg_hi:[0,0,1]
v_pk_fma_f32 v[48:49], v[48:49], v[226:227], v[228:229] neg_lo:[0,0,1] neg_hi:[0,0,1]
v_pk_fma_f32 v[50:51], v[50:51], v[226:227], v[228:229] neg_lo:[0,0,1] neg_hi:[0,0,1]
v_pk_fma_f32 v[52:53], v[52:53], v[226:227], v[228:229] neg_lo:[0,0,1] neg_hi:[0,0,1]
v_pk_fma_f32 v[54:55], v[54:55], v[226:227], v[228:229] neg_lo:[0,0,1] neg_hi:[0,0,1]
v_accvgpr_read_b32 v185, a153
v_accvgpr_read_b32 v244, a154
v_accvgpr_read_b32 v245, a155
v_accvgpr_read_b32 v246, a156
v_accvgpr_read_b32 v247, a157
s_movk_i32 s61, 1
s_cmp_lg_u32 s57, 0
s_cbranch_scc1 Lpoll_39
s_mov_b32 s61, 0x8000
Lpoll_39:
buffer_load_dword v186, v185, s[44:47], 0 offen offset:0 sc1
s_waitcnt vmcnt(0)
v_cmp_ne_u32 vcc, s55, v186
s_cbranch_vccz Lpd_40
s_sub_u32 s61, s61, 1
s_cmp_lg_u32 s61, 0
s_cbranch_scc1 Lpoll_39
s_mov_b32 s57, 1
Lpd_40:
buffer_load_dwordx4 v[64:67], v244, s[44:47], 0 offen offset:0 sc1
buffer_load_dwordx4 v[68:71], v244, s[44:47], 0 offen offset:1024 sc1
buffer_load_dwordx4 v[72:75], v244, s[44:47], 0 offen offset:2048 sc1
buffer_load_dwordx4 v[76:79], v244, s[44:47], 0 offen offset:3072 sc1
buffer_load_dwordx4 v[80:83], v245, s[44:47], 0 offen offset:0 sc1
buffer_load_dwordx4 v[84:87], v245, s[44:47], 0 offen offset:1024 sc1
s_waitcnt vmcnt(5) lgkmcnt(15)
v_mfma_f32_16x16x32_bf16 v[40:43], v[128:131], v[64:67], v[40:43]
s_nop 0
buffer_load_dwordx4 v[88:91], v245, s[44:47], 0 offen offset:2048 sc1
ds_read_b64_tr_b16 v[128:129], v192 offset:12288
ds_read_b64_tr_b16 v[130:131], v192 offset:14336
v_mfma_f32_16x16x32_bf16 v[44:47], v[132:135], v[64:67], v[44:47]
ds_read_b64_tr_b16 v[132:133], v193 offset:12288
ds_read_b64_tr_b16 v[134:135], v193 offset:14336
v_mfma_f32_16x16x32_bf16 v[48:51], v[136:139], v[64:67], v[48:51]
ds_read_b64_tr_b16 v[136:137], v194 offset:12288
ds_read_b64_tr_b16 v[138:139], v194 offset:14336
v_mfma_f32_16x16x32_bf16 v[52:55], v[140:143], v[64:67], v[52:55]
ds_read_b64_tr_b16 v[140:141], v195 offset:12288
ds_read_b64_tr_b16 v[142:143], v195 offset:14336
s_waitcnt vmcnt(5)
v_mfma_f32_16x16x32_bf16 v[40:43], v[144:147], v[68:71], v[40:43]
s_nop 0
buffer_load_dwordx4 v[92:95], v245, s[44:47], 0 offen offset:3072 sc1
ds_read_b64_tr_b16 v[144:145], v196 offset:0
ds_read_b64_tr_b16 v[146:147], v196 offset:2048
v_mfma_f32_16x16x32_bf16 v[44:47], v[148:151], v[68:71], v[44:47]
ds_read_b64_tr_b16 v[148:149], v197 offset:0
ds_read_b64_tr_b16 v[150:151], v197 offset:2048
v_mfma_f32_16x16x32_bf16 v[48:51], v[152:155], v[68:71], v[48:51]
ds_read_b64_tr_b16 v[152:153], v198 offset:0
ds_read_b64_tr_b16 v[154:155], v198 offset:2048
v_mfma_f32_16x16x32_bf16 v[52:55], v[156:159], v[68:71], v[52:55]
ds_read_b64_tr_b16 v[156:157], v199 offset:0
ds_read_b64_tr_b16 v[158:159], v199 offset:2048
s_waitcnt vmcnt(5) lgkmcnt(15)
v_mfma_f32_16x16x32_bf16 v[40:43], v[160:163], v[72:75], v[40:43]
ds_read_b64_tr_b16 v[160:161], v196 offset:4096
ds_read_b64_tr_b16 v[162:163], v196 offset:6144
v_mfma_f32_16x16x32_bf16 v[44:47], v[164:167], v[72:75], v[44:47]
ds_read_b64_tr_b16 v[164:165], v197 offset:4096
ds_read_b64_tr_b16 v[166:167], v197 offset:6144
v_mfma_f32_16x16x32_bf16 v[48:51], v[168:171], v[72:75], v[48:51]
ds_read_b64_tr_b16 v[168:169], v198 offset:4096
ds_read_b64_tr_b16 v[170:171], v198 offset:6144
v_mfma_f32_16x16x32_bf16 v[52:55], v[172:175], v[72:75], v[52:55]
ds_read_b64_tr_b16 v[172:173], v199 offset:4096
ds_read_b64_tr_b16 v[174:175], v199 offset:6144
s_waitcnt vmcnt(4)
v_mfma_f32_16x16x32_bf16 v[40:43], v[128:131], v[76:79], v[40:43]
ds_read_b64_tr_b16 v[128:129], v196 offset:8192
ds_read_b64_tr_b16 v[130:131], v196 offset:10240
v_mfma_f32_16x16x32_bf16 v[44:47], v[132:135], v[76:79], v[44:47]
ds_read_b64_tr_b16 v[132:133], v197 offset:8192
ds_read_b64_tr_b16 v[134:135], v197 offset:10240
v_mfma_f32_16x16x32_bf16 v[48:51], v[136:139], v[76:79], v[48:51]
ds_read_b64_tr_b16 v[136:137], v198 offset:8192
ds_read_b64_tr_b16 v[138:139], v198 offset:10240
v_mfma_f32_16x16x32_bf16 v[52:55], v[140:143], v[76:79], v[52:55]
ds_read_b64_tr_b16 v[140:141], v199 offset:8192
ds_read_b64_tr_b16 v[142:143], v199 offset:10240
s_cmp_eq_u32 s71, 0
s_cbranch_scc1 Lhw_41
s_mov_b32 s61, 0x8000
s_nop 2
Lhp_42:
s_load_dwordx8 s[8:15], s[44:45], s70 glc
s_waitcnt lgkmcnt(0)
s_cmp_eq_u32 s71, 1
s_cselect_b32 s8, s8, s10
s_cselect_b32 s9, s9, s11
s_cselect_b32 s10, s12, s14
s_cselect_b32 s11, s13, s15
s_xor_b32 s8, s8, s55
s_xor_b32 s9, s9, s55
s_xor_b32 s10, s10, s55
s_xor_b32 s11, s11, s55
s_or_b32 s8, s8, s9
s_or_b32 s10, s10, s11
s_or_b32 s8, s8, s10
s_cmp_eq_u32 s8, 0
s_cbranch_scc1 Lhq_43
s_sub_u32 s61, s61, 1
s_cmp_lg_u32 s61, 0
s_cbranch_scc1 Lhp_42
s_mov_b32 s57, 1
Lhq_43:
Lhw_41:
s_waitcnt vmcnt(3) lgkmcnt(15)
v_mfma_f32_16x16x32_bf16 v[40:43], v[144:147], v[80:83], v[40:43]
s_nop 0
buffer_load_dwordx4 v[96:99], v246, s[44:47], 0 offen offset:0 sc1
ds_read_b64_tr_b16 v[144:145], v196 offset:12288
ds_read_b64_tr_b16 v[146:147], v196 offset:14336
v_mfma_f32_16x16x32_bf16 v[44:47], v[148:151], v[80:83], v[44:47]
buffer_load_dwordx4 v[100:103], v246, s[44:47], 0 offen offset:1024 sc1
ds_read_b64_tr_b16 v[148:149], v197 offset:12288
ds_read_b64_tr_b16 v[150:151], v197 offset:14336
v_mfma_f32_16x16x32_bf16 v[48:51], v[152:155], v[80:83], v[48:51]
ds_read_b64_tr_b16 v[152:153], v198 offset:12288
ds_read_b64_tr_b16 v[154:155], v198 offset:14336
v_mfma_f32_16x16x32_bf16 v[52:55], v[156:159], v[80:83], v[52:55]
ds_read_b64_tr_b16 v[156:157], v199 offset:12288
ds_read_b64_tr_b16 v[158:159], v199 offset:14336
s_waitcnt vmcnt(4)
v_mfma_f32_16x16x32_bf16 v[40:43], v[160:163], v[84:87], v[40:43]
s_nop 0
buffer_load_dwordx4 v[104:107], v246, s[44:47], 0 offen offset:2048 sc1
ds_read_b64_tr_b16 v[160:161], v200 offset:0
ds_read_b64_tr_b16 v[162:163], v200 offset:2048
v_mfma_f32_16x16x32_bf16 v[44:47], v[164:167], v[84:87], v[44:47]
buffer_load_dwordx4 v[108:111], v246, s[44:47], 0 offen offset:3072 sc1
ds_read_b64_tr_b16 v[164:165], v201 offset:0
ds_read_b64_tr_b16 v[166:167], v201 offset:2048
v_mfma_f32_16x16x32_bf16 v[48:51], v[168:171], v[84:87], v[48:51]
ds_read_b64_tr_b16 v[168:169], v202 offset:0
ds_read_b64_tr_b16 v[170:171], v202 offset:2048
v_mfma_f32_16x16x32_bf16 v[52:55], v[172:175], v[84:87], v[52:55]
ds_read_b64_tr_b16 v[172:173], v203 offset:0
ds_read_b64_tr_b16 v[174:175], v203 offset:2048
s_waitcnt vmcnt(5) lgkmcnt(15)
v_mfma_f32_16x16x32_bf16 v[40:43], v[128:131], v[88:91], v[40:43]
s_nop 0
buffer_load_dwordx4 v[112:115], v247, s[44:47], 0 offen offset:0 sc1
ds_read_b64_tr_b16 v[128:129], v200 offset:4096
ds_read_b64_tr_b16 v[130:131], v200 offset:6144
v_mfma_f32_16x16x32_bf16 v[44:47], v[132:135], v[88:91], v[44:47]
buffer_load_dwordx4 v[116:119], v247, s[44:47], 0 offen offset:1024 sc1
ds_read_b64_tr_b16 v[132:133], v201 offset:4096
ds_read_b64_tr_b16 v[134:135], v201 offset:6144
v_mfma_f32_16x16x32_bf16 v[48:51], v[136:139], v[88:91], v[48:51]
ds_read_b64_tr_b16 v[136:137], v202 offset:4096
ds_read_b64_tr_b16 v[138:139], v202 offset:6144
v_mfma_f32_16x16x32_bf16 v[52:55], v[140:143], v[88:91], v[52:55]
ds_read_b64_tr_b16 v[140:141], v203 offset:4096
ds_read_b64_tr_b16 v[142:143], v203 offset:6144
s_waitcnt vmcnt(6)
v_mfma_f32_16x16x32_bf16 v[40:43], v[144:147], v[92:95], v[40:43]
s_nop 0
buffer_load_dwordx4 v[120:123], v247, s[44:47], 0 offen offset:2048 sc1
ds_read_b64_tr_b16 v[144:145], v200 offset:8192
ds_read_b64_tr_b16 v[146:147], v200 offset:10240
v_mfma_f32_16x16x32_bf16 v[44:47], v[148:151], v[92:95], v[44:47]
buffer_load_dwordx4 v[124:127], v247, s[44:47], 0 offen offset:3072 sc1
ds_read_b64_tr_b16 v[148:149], v201 offset:8192
ds_read_b64_tr_b16 v[150:151], v201 offset:10240
v_mfma_f32_16x16x32_bf16 v[48:51], v[152:155], v[92:95], v[48:51]
ds_read_b64_tr_b16 v[152:153], v202 offset:8192
ds_read_b64_tr_b16 v[154:155], v202 offset:10240
v_mfma_f32_16x16x32_bf16 v[52:55], v[156:159], v[92:95], v[52:55]
ds_read_b64_tr_b16 v[156:157], v203 offset:8192
ds_read_b64_tr_b16 v[158:159], v203 offset:10240
s_waitcnt vmcnt(7) lgkmcnt(15)
v_mfma_f32_16x16x32_bf16 v[40:43], v[160:163], v[96:99], v[40:43]
ds_read_b64_tr_b16 v[160:161], v200 offset:12288
ds_read_b64_tr_b16 v[162:163], v200 offset:14336
v_mfma_f32_16x16x32_bf16 v[44:47], v[164:167], v[96:99], v[44:47]
ds_read_b64_tr_b16 v[164:165], v201 offset:12288
ds_read_b64_tr_b16 v[166:167], v201 offset:14336
v_mfma_f32_16x16x32_bf16 v[48:51], v[168:171], v[96:99], v[48:51]
ds_read_b64_tr_b16 v[168:169], v202 offset:12288
ds_read_b64_tr_b16 v[170:171], v202 offset:14336
v_mfma_f32_16x16x32_bf16 v[52:55], v[172:175], v[96:99], v[52:55]
ds_read_b64_tr_b16 v[172:173], v203 offset:12288
ds_read_b64_tr_b16 v[174:175], v203 offset:14336
s_waitcnt vmcnt(6)
v_mfma_f32_16x16x32_bf16 v[40:43], v[128:131], v[100:103], v[40:43]
s_lshl_b32 s0, s49, 1
ds_read_b64_tr_b16 v[128:129], v204 offset:0
ds_read_b64_tr_b16 v[130:131], v204 offset:2048
v_mfma_f32_16x16x32_bf16 v[44:47], v[132:135], v[100:103], v[44:47]
s_add_u32 s0, s0, 1
s_and_b32 s0, s0, 7
ds_read_b64_tr_b16 v[132:133], v205 offset:0
ds_read_b64_tr_b16 v[134:135], v205 offset:2048
v_mfma_f32_16x16x32_bf16 v[48:51], v[136:139], v[100:103], v[48:51]
s_nop 0
s_mul_i32 s1, s0, 176128
ds_read_b64_tr_b16 v[136:137], v206 offset:0
ds_read_b64_tr_b16 v[138:139], v206 offset:2048
v_mfma_f32_16x16x32_bf16 v[52:55], v[140:143], v[100:103], v[52:55]
s_add_u32 m0, s60, 90112
s_nop 0
s_nop 0
buffer_load_dwordx4 v4, s[32:35], s1 offen offset:0 lds
ds_read_b64_tr_b16 v[140:141], v207 offset:0
ds_read_b64_tr_b16 v[142:143], v207 offset:2048
s_waitcnt vmcnt(6) lgkmcnt(15)
v_mfma_f32_16x16x32_bf16 v[40:43], v[144:147], v[104:107], v[40:43]
s_nop 0
buffer_load_dwordx4 v7, s[32:35], s1 offen offset:1024 lds
ds_read_b64_tr_b16 v[144:145], v204 offset:4096
ds_read_b64_tr_b16 v[146:147], v204 offset:6144
v_mfma_f32_16x16x32_bf16 v[44:47], v[148:151], v[104:107], v[44:47]
s_add_u32 m0, s60, 98304
s_add_u32 s3, s1, 128
ds_read_b64_tr_b16 v[148:149], v205 offset:4096
ds_read_b64_tr_b16 v[150:151], v205 offset:6144
v_mfma_f32_16x16x32_bf16 v[48:51], v[152:155], v[104:107], v[48:51]
buffer_load_dwordx4 v4, s[32:35], s3 offen offset:0 lds
ds_read_b64_tr_b16 v[152:153], v206 offset:4096
ds_read_b64_tr_b16 v[154:155], v206 offset:6144
v_mfma_f32_16x16x32_bf16 v[52:55], v[156:159], v[104:107], v[52:55]
buffer_load_dwordx4 v7, s[32:35], s3 offen offset:1024 lds
s_add_u32 m0, s60, 106496
ds_read_b64_tr_b16 v[156:157], v207 offset:4096
ds_read_b64_tr_b16 v[158:159], v207 offset:6144
s_waitcnt vmcnt(8)
v_mfma_f32_16x16x32_bf16 v[40:43], v[160:163], v[108:111], v[40:43]
s_nop 0
s_add_u32 s3, s1, 256
ds_read_b64_tr_b16 v[160:161], v204 offset:8192
ds_read_b64_tr_b16 v[162:163], v204 offset:10240
v_mfma_f32_16x16x32_bf16 v[44:47], v[164:167], v[108:111], v[44:47]
buffer_load_dwordx4 v5, s[32:35], s3 offen offset:0 lds
buffer_load_dwordx4 v12, s[32:35], s3 offen offset:1024 lds
ds_read_b64_tr_b16 v[164:165], v205 offset:8192
ds_read_b64_tr_b16 v[166:167], v205 offset:10240
v_mfma_f32_16x16x32_bf16 v[48:51], v[168:171], v[108:111], v[48:51]
ds_read_b64_tr_b16 v[168:169], v206 offset:8192
ds_read_b64_tr_b16 v[170:171], v206 offset:10240
v_mfma_f32_16x16x32_bf16 v[52:55], v[172:175], v[108:111], v[52:55]
ds_read_b64_tr_b16 v[172:173], v207 offset:8192
ds_read_b64_tr_b16 v[174:175], v207 offset:10240
s_waitcnt vmcnt(9) lgkmcnt(15)
v_mfma_f32_16x16x32_bf16 v[40:43], v[128:131], v[112:115], v[40:43]
ds_read_b64_tr_b16 v[128:129], v204 offset:12288
ds_read_b64_tr_b16 v[130:131], v204 offset:14336
v_mfma_f32_16x16x32_bf16 v[44:47], v[132:135], v[112:115], v[44:47]
ds_read_b64_tr_b16 v[132:133], v205 offset:12288
ds_read_b64_tr_b16 v[134:135], v205 offset:14336
v_mfma_f32_16x16x32_bf16 v[48:51], v[136:139], v[112:115], v[48:51]
ds_read_b64_tr_b16 v[136:137], v206 offset:12288
ds_read_b64_tr_b16 v[138:139], v206 offset:14336
v_mfma_f32_16x16x32_bf16 v[52:55], v[140:143], v[112:115], v[52:55]
ds_read_b64_tr_b16 v[140:141], v207 offset:12288
ds_read_b64_tr_b16 v[142:143], v207 offset:14336
s_waitcnt vmcnt(8)
v_mfma_f32_16x16x32_bf16 v[40:43], v[144:147], v[116:119], v[40:43]
v_mfma_f32_16x16x32_bf16 v[44:47], v[148:151], v[116:119], v[44:47]
v_mfma_f32_16x16x32_bf16 v[48:51], v[152:155], v[116:119], v[48:51]
v_mfma_f32_16x16x32_bf16 v[52:55], v[156:159], v[116:119], v[52:55]
s_waitcnt vmcnt(7) lgkmcnt(8)
v_mfma_f32_16x16x32_bf16 v[40:43], v[160:163], v[120:123], v[40:43]
v_mfma_f32_16x16x32_bf16 v[44:47], v[164:167], v[120:123], v[44:47]
v_mfma_f32_16x16x32_bf16 v[48:51], v[168:171], v[120:123], v[48:51]
v_mfma_f32_16x16x32_bf16 v[52:55], v[172:175], v[120:123], v[52:55]
s_waitcnt vmcnt(6) lgkmcnt(0)
v_mfma_f32_16x16x32_bf16 v[40:43], v[128:131], v[124:127], v[40:43]
v_mfma_f32_16x16x32_bf16 v[44:47], v[132:135], v[124:127], v[44:47]
v_mfma_f32_16x16x32_bf16 v[48:51], v[136:139], v[124:127], v[48:51]
v_mfma_f32_16x16x32_bf16 v[52:55], v[140:143], v[124:127], v[52:55]
s_nop 4
s_nop 0
v_cvt_pk_bf16_f32 v192, v40, v41
v_cvt_pk_bf16_f32 v193, v42, v43
v_cvt_pk_bf16_f32 v194, v44, v45
v_cvt_pk_bf16_f32 v195, v46, v47
v_cvt_pk_bf16_f32 v196, v48, v49
v_cvt_pk_bf16_f32 v197, v50, v51
v_cvt_pk_bf16_f32 v198, v52, v53
v_cvt_pk_bf16_f32 v199, v54, v55
s_cmp_eq_u32 s56, 0
s_cbranch_scc1 Lslow_44
buffer_store_dwordx4 v[192:195], v60, s[44:47], 0 offen
buffer_store_dwordx4 v[196:199], v60, s[44:47], 0 offen offset:1024
s_branch Lpub_45
Lslow_44:
s_nop 0
buffer_store_dwordx4 v[192:195], v60, s[44:47], 0 offen sc1
buffer_store_dwordx4 v[196:199], v60, s[44:47], 0 offen offset:1024 sc1
Lpub_45:
v_pk_add_f32 v[180:181], v[40:41], v[42:43]
v_pk_mul_f32 v[182:183], v[40:41], v[40:41]
v_pk_add_f32 v[184:185], v[44:45], v[46:47]
v_pk_mul_f32 v[186:187], v[44:45], v[44:45]
v_pk_fma_f32 v[182:183], v[42:43], v[42:43], v[182:183]
v_pk_fma_f32 v[186:187], v[46:47], v[46:47], v[186:187]
v_pk_add_f32 v[180:181], v[180:181], v[48:49]
v_pk_add_f32 v[184:185], v[184:185], v[50:51]
v_pk_fma_f32 v[182:183], v[48:49], v[48:49], v[182:183]
v_pk_fma_f32 v[186:187], v[50:51], v[50:51], v[186:187]
v_pk_add_f32 v[180:181], v[180:181], v[52:53]
v_pk_add_f32 v[184:185], v[184:185], v[54:55]
v_pk_fma_f32 v[182:183], v[52:53], v[52:53], v[182:183]
v_pk_fma_f32 v[186:187], v[54:55], v[54:55], v[186:187]
v_pk_add_f32 v[180:181], v[180:181], v[184:185]
v_pk_add_f32 v[182:183], v[182:183], v[186:187]
v_add_f32 v180, v180, v181
v_add_f32 v181, v182, v183
s_nop 1
v_permlane32_swap_b32 v180, v181
v_add_f32 v180, v180, v181
v_mov_b32 v181, v180
s_nop 1
v_permlane16_swap_b32 v180, v181
v_add_f32 v180, v180, v181
v_mov_b32 v181, v180
s_nop 1
v_permlane32_swap_b32 v180, v181
s_mov_b64 exec, 0xffff
s_cmp_eq_u32 s56, 0
s_cbranch_scc1 Lslow_46
buffer_store_dwordx2 v[180:181], v63, s[44:47], 0 offen offset:2048
s_branch Lpub_47
Lslow_46:
buffer_store_dwordx2 v[180:181], v63, s[44:47], 0 offen offset:2048 sc1
Lpub_47:
s_mov_b64 exec, -1
s_waitcnt vmcnt(0)
s_mov_b64 exec, 1
s_cmp_eq_u32 s56, 0
s_cbranch_scc1 Lslow_48
buffer_store_dword v9, v61, s[44:47], 0 offen offset:64
s_branch Lpub_49
Lslow_48:
buffer_store_dword v9, v61, s[44:47], 0 offen offset:64 sc1
Lpub_49:
s_mov_b64 exec, -1
s_barrier
v_lshlrev_b32 v208, 16, v232
v_and_b32 v209, 0xffff0000, v232
s_lshl_b32 s0, s49, 1
v_lshlrev_b32 v210, 16, v233
s_add_u32 s0, s0, 3
v_and_b32 v211, 0xffff0000, v233
s_and_b32 s0, s0, 7
v_lshlrev_b32_e64 v212, 16, v234
v_and_b32 v213, 0xffff0000, v234
s_mul_i32 s1, s0, 176128
v_lshlrev_b32_e64 v214, 16, v235
s_add_u32 m0, s60, 16384
v_and_b32 v215, 0xffff0000, v235
buffer_load_dwordx4 v4, s[32:35], s1 offen offset:0 lds
v_lshlrev_b32_e64 v216, 16, v236
v_and_b32 v217, 0xffff0000, v236
buffer_load_dwordx4 v7, s[32:35], s1 offen offset:1024 lds
v_lshlrev_b32_e64 v218, 16, v237
s_add_u32 m0, s60, 24576
v_and_b32 v219, 0xffff0000, v237
s_add_u32 s3, s1, 128
v_lshlrev_b32_e64 v220, 16, v238
v_and_b32 v221, 0xffff0000, v238
buffer_load_dwordx4 v4, s[32:35], s3 offen offset:0 lds
v_lshlrev_b32_e64 v222, 16, v239
buffer_load_dwordx4 v7, s[32:35], s3 offen offset:1024 lds
v_and_b32 v223, 0xffff0000, v239
s_add_u32 m0, s60, 32768
v_pk_add_f32 v[208:209], v[208:209], v[40:41]
s_add_u32 s3, s1, 256
v_pk_add_f32 v[210:211], v[210:211], v[42:43]
v_pk_add_f32 v[212:213], v[212:213], v[44:45]
buffer_load_dwordx4 v5, s[32:35], s3 offen offset:0 lds
v_pk_add_f32 v[214:215], v[214:215], v[46:47]
buffer_load_dwordx4 v12, s[32:35], s3 offen offset:1024 lds
v_pk_add_f32 v[216:217], v[216:217], v[48:49]
s_lshl_b32 s0, s49, 1
v_pk_add_f32 v[218:219], v[218:219], v[50:51]
v_pk_add_f32 v[220:221], v[220:221], v[52:53]
s_add_u32 s0, s0, 4
v_pk_add_f32 v[222:223], v[222:223], v[54:55]
s_and_b32 s0, s0, 7
s_nop 0
v_accvgpr_write_b32 a240, v208
s_mul_i32 s1, s0, 176128
v_accvgpr_write_b32 a241, v209
v_accvgpr_write_b32 a242, v210
s_add_u32 m0, s60, 40960
v_accvgpr_write_b32 a243, v211
buffer_load_dwordx4 v4, s[32:35], s1 offen offset:0 lds
v_accvgpr_write_b32 a244, v212
buffer_load_dwordx4 v7, s[32:35], s1 offen offset:1024 lds
v_accvgpr_write_b32 a245, v213
s_add_u32 m0, s60, 49152
v_accvgpr_write_b32 a246, v214
v_accvgpr_write_b32 a247, v215
s_add_u32 s3, s1, 128
v_accvgpr_write_b32 a248, v216
buffer_load_dwordx4 v4, s[32:35], s3 offen offset:0 lds
v_accvgpr_write_b32 a249, v217
buffer_load_dwordx4 v7, s[32:35], s3 offen offset:1024 lds
v_accvgpr_write_b32 a250, v218
v_accvgpr_write_b32 a251, v219
s_add_u32 m0, s60, 57344
v_accvgpr_write_b32 a252, v220
s_add_u32 s3, s1, 256
v_accvgpr_write_b32 a253, v221
buffer_load_dwordx4 v5, s[32:35], s3 offen offset:0 lds
v_accvgpr_write_b32 a254, v222
v_accvgpr_write_b32 a255, v223
buffer_load_dwordx4 v12, s[32:35], s3 offen offset:1024 lds
v_mov_b32 v112, v62
v_mov_b32 v113, v61
s_lshl_b32 s62, s52, 5
v_xor_b32 v108, s62, v14
v_add_u32 v109, 0x10000, v108
v_add_u32 v110, 0x10000, v1
v_add_u32 v111, 0x20000, v108
s_lshl_b32 s62, s52, 7
v_lshlrev_b32 v104, 4, v2
v_add_u32 v104, 156672, v104
v_add_u32 v105, s62, v104
v_add_u32 v105, s62, v105
s_lshr_b32 s62, s52, 1
s_lshl_b32 s62, s62, 10
s_and_b32 s63, s52, 1
s_lshl_b32 s63, s63, 3
s_add_u32 s62, s62, s63
s_add_u32 s62, s62, 131072
v_add_u32 v116, s62, v1
s_mul_i32 s62, s52, 6144
s_add_u32 s62, s62, 131072
v_add_u32 v117, s62, v1
s_lshr_b32 s62, s87, 5
s_add_u32 s62, s62, 43
s_sub_u32 s62, s62, s19
s_add_u32 s8, s62, 0
s_sub_u32 s63, s8, 43
s_cmp_lt_u32 s8, 43
s_cselect_b32 s8, s8, s63
s_lshl_b32 s8, s8, 10
s_add_u32 s9, s62, 1
s_sub_u32 s63, s9, 43
s_cmp_lt_u32 s9, 43
s_cselect_b32 s9, s9, s63
s_lshl_b32 s9, s9, 10
s_add_u32 s10, s62, 2
s_sub_u32 s63, s10, 43
s_cmp_lt_u32 s10, 43
s_cselect_b32 s10, s10, s63
s_lshl_b32 s10, s10, 10
s_add_u32 s11, s62, 3
s_sub_u32 s63, s11, 43
s_cmp_lt_u32 s11, 43
s_cselect_b32 s11, s11, s63
s_lshl_b32 s11, s11, 10
s_add_u32 s12, s62, 4
s_sub_u32 s63, s12, 43
s_cmp_lt_u32 s12, 43
s_cselect_b32 s12, s12, s63
s_lshl_b32 s12, s12, 10
s_add_u32 s13, s62, 5
s_sub_u32 s63, s13, 43
s_cmp_lt_u32 s13, 43
s_cselect_b32 s13, s13, s63
s_lshl_b32 s13, s13, 10
s_cmp_eq_u32 s88, 8
s_cselect_b32 s13, s13, 0x40000000
v_accvgpr_read_b32 v118, a158
s_movk_i32 s61, 1
s_cmp_lg_u32 s57, 0
s_cbranch_scc1 Lpoll_50
s_mov_b32 s61, 0x8000
Lpoll_50:
buffer_load_dword v185, v112, s[44:47], 0 offen offset:64 sc1
s_waitcnt vmcnt(0)
v_cmp_ne_u32 vcc, s55, v185
s_cbranch_vccz Lpd_51
s_sub_u32 s61, s61, 1
s_cmp_lg_u32 s61, 0
s_cbranch_scc1 Lpoll_50
s_mov_b32 s57, 1
Lpd_51:
s_lshl_b32 s0, s49, 1
s_add_u32 s0, s0, 0
s_and_b32 s0, s0, 7
s_lshl_b32 s0, s0, 11
s_add_u32 s0, s0, s99
s_add_u32 m0, s60, 114688
s_nop 0
buffer_load_dwordx4 v1, s[44:47], s0 offen offset:0 sc1 lds
buffer_load_dwordx4 v1, s[44:47], s0 offen offset:1024 sc1 lds
buffer_load_dwordx4 v[188:191], v224, s[44:47], 0 offen offset:2048 sc1
s_lshl_b32 s0, s49, 1
s_add_u32 s0, s0, 1
s_and_b32 s0, s0, 7
s_lshl_b32 s0, s0, 11
s_add_u32 s0, s0, s99
s_add_u32 m0, s60, 122880
s_nop 0
buffer_load_dwordx4 v1, s[44:47], s0 offen offset:0 sc1 lds
buffer_load_dwordx4 v1, s[44:47], s0 offen offset:1024 sc1 lds
s_waitcnt vmcnt(3)
s_barrier
ds_read_b128 v[40:43], v110 offset:49152
ds_read_b128 v[44:47], v110 offset:51200
ds_read_b128 v[48:51], v110 offset:53248
ds_read_b128 v[52:55], v110 offset:55296
ds_read_b64_tr_b16 v[192:193], v109 offset:0
ds_read_b64_tr_b16 v[194:195], v109 offset:2048
ds_read_b64_tr_b16 v[196:197], v109 offset:8192
ds_read_b64_tr_b16 v[198:199], v109 offset:10240
ds_read_b64_tr_b16 v[200:201], v109 offset:16384
ds_read_b64_tr_b16 v[202:203], v109 offset:18432
ds_read_b128 v[56:59], v110 offset:50176
ds_read_b128 v[60:63], v110 offset:52224
ds_read_b128 v[64:67], v110 offset:54272
ds_read_b128 v[68:71], v110 offset:56320
ds_read_b64_tr_b16 v[204:205], v109 offset:4096
ds_read_b64_tr_b16 v[206:207], v109 offset:6144
ds_read_b64_tr_b16 v[208:209], v109 offset:12288
ds_read_b64_tr_b16 v[210:211], v109 offset:14336
ds_read_b64_tr_b16 v[212:213], v109 offset:20480
ds_read_b64_tr_b16 v[214:215], v109 offset:22528
s_waitcnt vmcnt(0)
s_barrier
s_waitcnt lgkmcnt(0)
v_mfma_f32_16x16x32_bf16 v[128:131], v[192:195], v[40:43], 0
v_pk_add_f32 v[188:189], v[188:189], v[190:191]
v_mfma_f32_16x16x32_bf16 v[132:135], v[192:195], v[44:47], 0
ds_read_b128 v[72:75], v110 offset:57344
s_lshl_b32 s0, s49, 1
v_permlane32_swap_b32 v188, v189
v_mfma_f32_16x16x32_bf16 v[136:139], v[192:195], v[48:51], 0
ds_read_b128 v[76:79], v110 offset:59392
v_add_f32 v188, v188, v189
v_mfma_f32_16x16x32_bf16 v[140:143], v[192:195], v[52:55], 0
ds_read_b128 v[80:83], v110 offset:61440
s_add_u32 s0, s0, 2
v_mov_b32 v189, v188
v_mfma_f32_16x16x32_bf16 v[176:179], v[192:195], v[20:23], 0
ds_read_b128 v[84:87], v110 offset:63488
v_permlane16_swap_b32 v188, v189
v_mfma_f32_16x16x32_bf16 v[144:147], v[196:199], v[40:43], 0
s_and_b32 s0, s0, 7
v_add_f32 v188, v188, v189
v_mov_b32 v189, v188
v_mfma_f32_16x16x32_bf16 v[148:151], v[196:199], v[44:47], 0
ds_read_b64_tr_b16 v[216:217], v109 offset:24576
v_permlane32_swap_b32 v188, v189
v_mfma_f32_16x16x32_bf16 v[152:155], v[196:199], v[48:51], 0
ds_read_b64_tr_b16 v[218:219], v109 offset:26624
s_lshl_b32 s0, s0, 11
v_mul_f32_e64 v120, s83, v188
v_mfma_f32_16x16x32_bf16 v[156:159], v[196:199], v[52:55], 0
ds_read_b64_tr_b16 v[220:221], v109 offset:32768
v_mul_f32_e64 v189, s83, v189
v_mfma_f32_16x16x32_bf16 v[180:183], v[196:199], v[20:23], 0
ds_read_b64_tr_b16 v[222:223], v109 offset:34816
s_add_u32 s0, s0, s99
v_fma_f32 v189, -v120, v120, v189
v_mfma_f32_16x16x32_bf16 v[160:163], v[200:203], v[40:43], 0
s_add_u32 m0, s60, 0
v_max_f32 v189, 0, v189
v_add_f32 v190, s82, v189
v_mfma_f32_16x16x32_bf16 v[164:167], v[200:203], v[44:47], 0
ds_read_b64_tr_b16 v[224:225], v109 offset:40960
v_rsq_f32_e64 v122, v190
v_mfma_f32_16x16x32_bf16 v[168:171], v[200:203], v[48:51], 0
ds_read_b64_tr_b16 v[226:227], v109 offset:43008
buffer_load_dwordx4 v1, s[44:47], s0 offen offset:0 sc1 lds
v_mov_b32_e64 v121, v120
v_mfma_f32_16x16x32_bf16 v[172:175], v[200:203], v[52:55], 0
ds_read_b128 v[88:91], v110 offset:58368
v_mov_b32_e64 v123, v122
v_mfma_f32_16x16x32_bf16 v[184:187], v[200:203], v[20:23], 0
ds_read_b128 v[92:95], v110 offset:60416
buffer_load_dwordx4 v1, s[44:47], s0 offen offset:1024 sc1 lds
ds_write_b128 v105, v[120:123]
v_mfma_f32_16x16x32_bf16 v[128:131], v[204:207], v[56:59], v[128:131]
s_branch Lpg_6_n
.p2align 12
Lpg_6:
s_setpc_b64 s[100:101]
s_nop 0
Lpg_6_n:
v_mfma_f32_16x16x32_bf16 v[132:135], v[204:207], v[60:63], v[132:135]
ds_read_b128 v[96:99], v110 offset:62464
s_lshl_b32 s0, s49, 1
v_mfma_f32_16x16x32_bf16 v[136:139], v[204:207], v[64:67], v[136:139]
ds_read_b128 v[100:103], v110 offset:64512
v_mfma_f32_16x16x32_bf16 v[140:143], v[204:207], v[68:71], v[140:143]
ds_read_b64_tr_b16 v[228:229], v109 offset:28672
s_add_u32 s0, s0, 3
v_mfma_f32_16x16x32_bf16 v[176:179], v[204:207], v[20:23], v[176:179]
ds_read_b64_tr_b16 v[230:231], v109 offset:30720
s_and_b32 s0, s0, 7
v_mfma_f32_16x16x32_bf16 v[144:147], v[208:211], v[56:59], v[144:147]
v_mfma_f32_16x16x32_bf16 v[148:151], v[208:211], v[60:63], v[148:151]
ds_read_b64_tr_b16 v[232:233], v109 offset:36864
s_lshl_b32 s0, s0, 11
v_mfma_f32_16x16x32_bf16 v[152:155], v[208:211], v[64:67], v[152:155]
ds_read_b64_tr_b16 v[234:235], v109 offset:38912
v_mfma_f32_16x16x32_bf16 v[156:159], v[208:211], v[68:71], v[156:159]
ds_read_b64_tr_b16 v[236:237], v109 offset:45056
s_add_u32 s0, s0, s99
v_mfma_f32_16x16x32_bf16 v[180:183], v[208:211], v[20:23], v[180:183]
ds_read_b64_tr_b16 v[238:239], v109 offset:47104
v_mfma_f32_16x16x32_bf16 v[160:163], v[212:215], v[56:59], v[160:163]
s_add_u32 m0, s60, 8192
v_mfma_f32_16x16x32_bf16 v[164:167], v[212:215], v[60:63], v[164:167]
v_mfma_f32_16x16x32_bf16 v[168:171], v[212:215], v[64:67], v[168:171]
buffer_load_dwordx4 v1, s[44:47], s0 offen offset:0 sc1 lds
v_mfma_f32_16x16x32_bf16 v[172:175], v[212:215], v[68:71], v[172:175]
v_mfma_f32_16x16x32_bf16 v[184:187], v[212:215], v[20:23], v[184:187]
buffer_load_dwordx4 v1, s[44:47], s0 offen offset:1024 sc1 lds
s_waitcnt vmcnt(2) lgkmcnt(8)
s_barrier
v_mfma_f32_16x16x32_bf16 v[128:131], v[216:219], v[72:75], v[128:131]
v_mfma_f32_16x16x32_bf16 v[132:135], v[216:219], v[76:79], v[132:135]
ds_read_b128 v[40:43], v1 offset:0
s_lshl_b32 s0, s49, 1
v_mfma_f32_16x16x32_bf16 v[136:139], v[216:219], v[80:83], v[136:139]
ds_read_b128 v[44:47], v1 offset:2048
s_add_u32 s0, s0, 4
v_mfma_f32_16x16x32_bf16 v[140:143], v[216:219], v[84:87], v[140:143]
ds_read_b128 v[48:51], v1 offset:4096
s_and_b32 s0, s0, 7
v_mfma_f32_16x16x32_bf16 v[176:179], v[216:219], v[20:23], v[176:179]
ds_read_b128 v[52:55], v1 offset:6144
v_mfma_f32_16x16x32_bf16 v[144:147], v[220:223], v[72:75], v[144:147]
s_lshl_b32 s0, s0, 11
v_mfma_f32_16x16x32_bf16 v[148:151], v[220:223], v[76:79], v[148:151]
ds_read_b64_tr_b16 v[192:193], v111 offset:0
s_add_u32 s0, s0, s99
v_mfma_f32_16x16x32_bf16 v[152:155], v[220:223], v[80:83], v[152:155]
ds_read_b64_tr_b16 v[194:195], v111 offset:2048
s_add_u32 m0, s60, 114688
v_mfma_f32_16x16x32_bf16 v[156:159], v[220:223], v[84:87], v[156:159]
ds_read_b64_tr_b16 v[196:197], v111 offset:8192
buffer_load_dwordx4 v1, s[44:47], s0 offen offset:0 sc1 lds
v_mfma_f32_16x16x32_bf16 v[180:183], v[220:223], v[20:23], v[180:183]
ds_read_b64_tr_b16 v[198:199], v111 offset:10240
v_mfma_f32_16x16x32_bf16 v[160:163], v[224:227], v[72:75], v[160:163]
buffer_load_dwordx4 v1, s[44:47], s0 offen offset:1024 sc1 lds
v_mfma_f32_16x16x32_bf16 v[164:167], v[224:227], v[76:79], v[164:167]
ds_read_b64_tr_b16 v[200:201], v111 offset:16384
s_lshl_b32 s0, s49, 1
v_mfma_f32_16x16x32_bf16 v[168:171], v[224:227], v[80:83], v[168:171]
ds_read_b64_tr_b16 v[202:203], v111 offset:18432
s_add_u32 s0, s0, 5
v_mfma_f32_16x16x32_bf16 v[172:175], v[224:227], v[84:87], v[172:175]
ds_read_b128 v[56:59], v1 offset:1024
s_and_b32 s0, s0, 7
v_mfma_f32_16x16x32_bf16 v[184:187], v[224:227], v[20:23], v[184:187]
ds_read_b128 v[60:63], v1 offset:3072
v_mfma_f32_16x16x32_bf16 v[128:131], v[228:231], v[88:91], v[128:131]
s_mul_i32 s1, s0, 176128
v_mfma_f32_16x16x32_bf16 v[132:135], v[228:231], v[92:95], v[132:135]
ds_read_b128 v[64:67], v1 offset:5120
s_add_u32 m0, s60, 65536
v_mfma_f32_16x16x32_bf16 v[136:139], v[228:231], v[96:99], v[136:139]
ds_read_b128 v[68:71], v1 offset:7168
buffer_load_dwordx4 v4, s[32:35], s1 offen offset:0 lds
v_mfma_f32_16x16x32_bf16 v[140:143], v[228:231], v[100:103], v[140:143]
ds_read_b64_tr_b16 v[204:205], v111 offset:4096
buffer_load_dwordx4 v7, s[32:35], s1 offen offset:1024 lds
v_mfma_f32_16x16x32_bf16 v[176:179], v[228:231], v[20:23], v[176:179]
ds_read_b64_tr_b16 v[206:207], v111 offset:6144
v_mfma_f32_16x16x32_bf16 v[144:147], v[232:235], v[88:91], v[144:147]
s_add_u32 m0, s60, 73728
v_mfma_f32_16x16x32_bf16 v[148:151], v[232:235], v[92:95], v[148:151]
ds_read_b64_tr_b16 v[208:209], v111 offset:12288
s_add_u32 s3, s1, 128
v_mfma_f32_16x16x32_bf16 v[152:155], v[232:235], v[96:99], v[152:155]
ds_read_b64_tr_b16 v[210:211], v111 offset:14336
buffer_load_dwordx4 v4, s[32:35], s3 offen offset:0 lds
v_mfma_f32_16x16x32_bf16 v[156:159], v[232:235], v[100:103], v[156:159]
ds_read_b64_tr_b16 v[212:213], v111 offset:20480
buffer_load_dwordx4 v7, s[32:35], s3 offen offset:1024 lds
v_mfma_f32_16x16x32_bf16 v[180:183], v[232:235], v[20:23], v[180:183]
ds_read_b64_tr_b16 v[214:215], v111 offset:22528
v_mfma_f32_16x16x32_bf16 v[160:163], v[236:239], v[88:91], v[160:163]
s_add_u32 m0, s60, 81920
v_mfma_f32_16x16x32_bf16 v[164:167], v[236:239], v[92:95], v[164:167]
s_add_u32 s3, s1, 256
v_mfma_f32_16x16x32_bf16 v[168:171], v[236:239], v[96:99], v[168:171]
buffer_load_dwordx4 v5, s[32:35], s3 offen offset:0 lds
v_mfma_f32_16x16x32_bf16 v[172:175], v[236:239], v[100:103], v[172:175]
buffer_load_dwordx4 v12, s[32:35], s3 offen offset:1024 lds
v_mfma_f32_16x16x32_bf16 v[184:187], v[236:239], v[20:23], v[184:187]
s_waitcnt vmcnt(8)
s_barrier
s_waitcnt lgkmcnt(0)
v_mfma_f32_16x16x32_bf16 v[128:131], v[192:195], v[40:43], v[128:131]
v_mfma_f32_16x16x32_bf16 v[132:135], v[192:195], v[44:47], v[132:135]
ds_read_b128 v[72:75], v1 offset:8192
s_lshl_b32 s0, s49, 1
v_mfma_f32_16x16x32_bf16 v[136:139], v[192:195], v[48:51], v[136:139]
ds_read_b128 v[76:79], v1 offset:10240
s_add_u32 s0, s0, 5
v_mfma_f32_16x16x32_bf16 v[140:143], v[192:195], v[52:55], v[140:143]
ds_read_b128 v[80:83], v1 offset:12288
s_and_b32 s0, s0, 7
v_mfma_f32_16x16x32_bf16 v[176:179], v[192:195], v[20:23], v[176:179]
ds_read_b128 v[84:87], v1 offset:14336
s_lshl_b32 s0, s0, 11
v_mfma_f32_16x16x32_bf16 v[144:147], v[196:199], v[40:43], v[144:147]
s_add_u32 s0, s0, s99
v_mfma_f32_16x16x32_bf16 v[148:151], v[196:199], v[44:47], v[148:151]
ds_read_b64_tr_b16 v[216:217], v108 offset:16384
s_add_u32 m0, s60, 122880
v_mfma_f32_16x16x32_bf16 v[152:155], v[196:199], v[48:51], v[152:155]
ds_read_b64_tr_b16 v[218:219], v108 offset:18432
v_mfma_f32_16x16x32_bf16 v[156:159], v[196:199], v[52:55], v[156:159]
ds_read_b64_tr_b16 v[220:221], v108 offset:24576
buffer_load_dwordx4 v1, s[44:47], s0 offen offset:0 sc1 lds
v_mfma_f32_16x16x32_bf16 v[180:183], v[196:199], v[20:23], v[180:183]
ds_read_b64_tr_b16 v[222:223], v108 offset:26624
buffer_load_dwordx4 v1, s[44:47], s0 offen offset:1024 sc1 lds
v_mfma_f32_16x16x32_bf16 v[160:163], v[200:203], v[40:43], v[160:163]
s_lshl_b32 s0, s49, 1
v_mfma_f32_16x16x32_bf16 v[164:167], v[200:203], v[44:47], v[164:167]
ds_read_b64_tr_b16 v[224:225], v108 offset:32768
s_add_u32 s0, s0, 6
v_mfma_f32_16x16x32_bf16 v[168:171], v[200:203], v[48:51], v[168:171]
ds_read_b64_tr_b16 v[226:227], v108 offset:34816
s_and_b32 s0, s0, 7
v_mfma_f32_16x16x32_bf16 v[172:175], v[200:203], v[52:55], v[172:175]
ds_read_b128 v[88:91], v1 offset:9216
s_mul_i32 s1, s0, 176128
v_mfma_f32_16x16x32_bf16 v[184:187], v[200:203], v[20:23], v[184:187]
ds_read_b128 v[92:95], v1 offset:11264
v_mfma_f32_16x16x32_bf16 v[128:131], v[204:207], v[56:59], v[128:131]
s_add_u32 m0, s60, 90112
v_mfma_f32_16x16x32_bf16 v[132:135], v[204:207], v[60:63], v[132:135]
ds_read_b128 v[96:99], v1 offset:13312
buffer_load_dwordx4 v4, s[32:35], s1 offen offset:0 lds
v_mfma_f32_16x16x32_bf16 v[136:139], v[204:207], v[64:67], v[136:139]
ds_read_b128 v[100:103], v1 offset:15360
buffer_load_dwordx4 v7, s[32:35], s1 offen offset:1024 lds
v_mfma_f32_16x16x32_bf16 v[140:143], v[204:207], v[68:71], v[140:143]
ds_read_b64_tr_b16 v[228:229], v108 offset:20480
s_add_u32 m0, s60, 98304
v_mfma_f32_16x16x32_bf16 v[176:179], v[204:207], v[20:23], v[176:179]
ds_read_b64_tr_b16 v[230:231], v108 offset:22528
s_add_u32 s3, s1, 128
v_mfma_f32_16x16x32_bf16 v[144:147], v[208:211], v[56:59], v[144:147]
buffer_load_dwordx4 v4, s[32:35], s3 offen offset:0 lds
v_mfma_f32_16x16x32_bf16 v[148:151], v[208:211], v[60:63], v[148:151]
ds_read_b64_tr_b16 v[232:233], v108 offset:28672
v_mfma_f32_16x16x32_bf16 v[152:155], v[208:211], v[64:67], v[152:155]
ds_read_b64_tr_b16 v[234:235], v108 offset:30720
buffer_load_dwordx4 v7, s[32:35], s3 offen offset:1024 lds
v_mfma_f32_16x16x32_bf16 v[156:159], v[208:211], v[68:71], v[156:159]
ds_read_b64_tr_b16 v[236:237], v108 offset:36864
s_add_u32 m0, s60, 106496
v_mfma_f32_16x16x32_bf16 v[180:183], v[208:211], v[20:23], v[180:183]
ds_read_b64_tr_b16 v[238:239], v108 offset:38912
s_add_u32 s3, s1, 256
v_mfma_f32_16x16x32_bf16 v[160:163], v[212:215], v[56:59], v[160:163]
buffer_load_dwordx4 v5, s[32:35], s3 offen offset:0 lds
v_mfma_f32_16x16x32_bf16 v[164:167], v[212:215], v[60:63], v[164:167]
buffer_load_dwordx4 v12, s[32:35], s3 offen offset:1024 lds
v_mfma_f32_16x16x32_bf16 v[168:171], v[212:215], v[64:67], v[168:171]
v_accvgpr_read_b32 v114, a162
v_mfma_f32_16x16x32_bf16 v[172:175], v[212:215], v[68:71], v[172:175]
v_mfma_f32_16x16x32_bf16 v[184:187], v[212:215], v[20:23], v[184:187]
buffer_load_dword a200, v114, s[44:47], 0 offen
s_waitcnt vmcnt(15)
s_barrier
s_waitcnt lgkmcnt(0)
v_mfma_f32_16x16x32_bf16 v[128:131], v[216:219], v[72:75], v[128:131]
v_mfma_f32_16x16x32_bf16 v[132:135], v[216:219], v[76:79], v[132:135]
ds_read_b128 v[40:43], v110 offset:49152
s_lshl_b32 s0, s49, 1
v_mfma_f32_16x16x32_bf16 v[136:139], v[216:219], v[80:83], v[136:139]
ds_read_b128 v[44:47], v110 offset:51200
s_add_u32 s0, s0, 6
v_mfma_f32_16x16x32_bf16 v[140:143], v[216:219], v[84:87], v[140:143]
ds_read_b128 v[48:51], v110 offset:53248
s_and_b32 s0, s0, 7
v_mfma_f32_16x16x32_bf16 v[176:179], v[216:219], v[20:23], v[176:179]
ds_read_b128 v[52:55], v110 offset:55296
v_mfma_f32_16x16x32_bf16 v[144:147], v[220:223], v[72:75], v[144:147]
s_lshl_b32 s0, s0, 11
v_mfma_f32_16x16x32_bf16 v[148:151], v[220:223], v[76:79], v[148:151]
ds_read_b64_tr_b16 v[192:193], v108 offset:40960
s_add_u32 s0, s0, s99
v_mfma_f32_16x16x32_bf16 v[152:155], v[220:223], v[80:83], v[152:155]
ds_read_b64_tr_b16 v[194:195], v108 offset:43008
s_add_u32 m0, s60, 0
v_mfma_f32_16x16x32_bf16 v[156:159], v[220:223], v[84:87], v[156:159]
ds_read_b64_tr_b16 v[196:197], v108 offset:49152
buffer_load_dwordx4 v1, s[44:47], s0 offen offset:0 sc1 lds
v_mfma_f32_16x16x32_bf16 v[180:183], v[220:223], v[20:23], v[180:183]
ds_read_b64_tr_b16 v[198:199], v108 offset:51200
v_mfma_f32_16x16x32_bf16 v[160:163], v[224:227], v[72:75], v[160:163]
buffer_load_dwordx4 v1, s[44:47], s0 offen offset:1024 sc1 lds
v_mfma_f32_16x16x32_bf16 v[164:167], v[224:227], v[76:79], v[164:167]
ds_read_b64_tr_b16 v[200:201], v108 offset:57344
s_lshl_b32 s0, s49, 1
v_mfma_f32_16x16x32_bf16 v[168:171], v[224:227], v[80:83], v[168:171]
ds_read_b64_tr_b16 v[202:203], v108 offset:59392
s_add_u32 s0, s0, 7
v_mfma_f32_16x16x32_bf16 v[172:175], v[224:227], v[84:87], v[172:175]
ds_read_b128 v[56:59], v110 offset:50176
s_and_b32 s0, s0, 7
v_mfma_f32_16x16x32_bf16 v[184:187], v[224:227], v[20:23], v[184:187]
ds_read_b128 v[60:63], v110 offset:52224
v_mfma_f32_16x16x32_bf16 v[128:131], v[228:231], v[88:91], v[128:131]
s_mul_i32 s1, s0, 176128
v_mfma_f32_16x16x32_bf16 v[132:135], v[228:231], v[92:95], v[132:135]
ds_read_b128 v[64:67], v110 offset:54272
s_add_u32 m0, s60, 131072
v_mfma_f32_16x16x32_bf16 v[136:139], v[228:231], v[96:99], v[136:139]
ds_read_b128 v[68:71], v110 offset:56320
buffer_load_dwordx4 v4, s[32:35], s1 offen offset:0 lds
v_mfma_f32_16x16x32_bf16 v[140:143], v[228:231], v[100:103], v[140:143]
ds_read_b64_tr_b16 v[204:205], v108 offset:45056
buffer_load_dwordx4 v7, s[32:35], s1 offen offset:1024 lds
v_mfma_f32_16x16x32_bf16 v[176:179], v[228:231], v[20:23], v[176:179]
ds_read_b64_tr_b16 v[206:207], v108 offset:47104
v_mfma_f32_16x16x32_bf16 v[144:147], v[232:235], v[88:91], v[144:147]
s_add_u32 m0, s60, 139264
v_mfma_f32_16x16x32_bf16 v[148:151], v[232:235], v[92:95], v[148:151]
ds_read_b64_tr_b16 v[208:209], v108 offset:53248
s_add_u32 s3, s1, 128
v_mfma_f32_16x16x32_bf16 v[152:155], v[232:235], v[96:99], v[152:155]
ds_read_b64_tr_b16 v[210:211], v108 offset:55296
buffer_load_dwordx4 v4, s[32:35], s3 offen offset:0 lds
v_mfma_f32_16x16x32_bf16 v[156:159], v[232:235], v[100:103], v[156:159]
ds_read_b64_tr_b16 v[212:213], v108 offset:61440
buffer_load_dwordx4 v7, s[32:35], s3 offen offset:1024 lds
v_mfma_f32_16x16x32_bf16 v[180:183], v[232:235], v[20:23], v[180:183]
ds_read_b64_tr_b16 v[214:215], v108 offset:63488
v_mfma_f32_16x16x32_bf16 v[160:163], v[236:239], v[88:91], v[160:163]
s_add_u32 m0, s60, 147456
v_mfma_f32_16x16x32_bf16 v[164:167], v[236:239], v[92:95], v[164:167]
s_add_u32 s3, s1, 256
v_mfma_f32_16x16x32_bf16 v[168:171], v[236:239], v[96:99], v[168:171]
buffer_load_dwordx4 v5, s[32:35], s3 offen offset:0 lds
v_mfma_f32_16x16x32_bf16 v[172:175], v[236:239], v[100:103], v[172:175]
buffer_load_dwordx4 v12, s[32:35], s3 offen offset:1024 lds
v_mfma_f32_16x16x32_bf16 v[184:187], v[236:239], v[20:23], v[184:187]
s_waitcnt vmcnt(15)
s_barrier
s_waitcnt lgkmcnt(0)
v_mfma_f32_16x16x32_bf16 v[128:131], v[192:195], v[40:43], v[128:131]
v_mfma_f32_16x16x32_bf16 v[132:135], v[192:195], v[44:47], v[132:135]
ds_read_b128 v[72:75], v110 offset:57344
s_lshl_b32 s0, s49, 1
v_mfma_f32_16x16x32_bf16 v[136:139], v[192:195], v[48:51], v[136:139]
ds_read_b128 v[76:79], v110 offset:59392
v_mfma_f32_16x16x32_bf16 v[140:143], v[192:195], v[52:55], v[140:143]
ds_read_b128 v[80:83], v110 offset:61440
s_add_u32 s0, s0, 7
v_mfma_f32_16x16x32_bf16 v[176:179], v[192:195], v[20:23], v[176:179]
ds_read_b128 v[84:87], v110 offset:63488
s_and_b32 s0, s0, 7
v_mfma_f32_16x16x32_bf16 v[144:147], v[196:199], v[40:43], v[144:147]
v_mfma_f32_16x16x32_bf16 v[148:151], v[196:199], v[44:47], v[148:151]
ds_read_b64_tr_b16 v[216:217], v109 offset:0
s_lshl_b32 s0, s0, 11
v_mfma_f32_16x16x32_bf16 v[152:155], v[196:199], v[48:51], v[152:155]
ds_read_b64_tr_b16 v[218:219], v109 offset:2048
v_mfma_f32_16x16x32_bf16 v[156:159], v[196:199], v[52:55], v[156:159]
ds_read_b64_tr_b16 v[220:221], v109 offset:8192
s_add_u32 s0, s0, s99
v_mfma_f32_16x16x32_bf16 v[180:183], v[196:199], v[20:23], v[180:183]
ds_read_b64_tr_b16 v[222:223], v109 offset:10240
s_add_u32 m0, s60, 8192
v_mfma_f32_16x16x32_bf16 v[160:163], v[200:203], v[40:43], v[160:163]
v_mfma_f32_16x16x32_bf16 v[164:167], v[200:203], v[44:47], v[164:167]
ds_read_b64_tr_b16 v[224:225], v109 offset:16384
buffer_load_dwordx4 v1, s[44:47], s0 offen offset:0 sc1 lds
v_mfma_f32_16x16x32_bf16 v[168:171], v[200:203], v[48:51], v[168:171]
ds_read_b64_tr_b16 v[226:227], v109 offset:18432
buffer_load_dwordx4 v1, s[44:47], s0 offen offset:1024 sc1 lds
v_mfma_f32_16x16x32_bf16 v[172:175], v[200:203], v[52:55], v[172:175]
ds_read_b128 v[88:91], v110 offset:58368
v_mfma_f32_16x16x32_bf16 v[184:187], v[200:203], v[20:23], v[184:187]
ds_read_b128 v[92:95], v110 offset:60416
s_add_u32 s0, s89, 0
v_mfma_f32_16x16x32_bf16 v[128:131], v[204:207], v[56:59], v[128:131]
v_mfma_f32_16x16x32_bf16 v[132:135], v[204:207], v[60:63], v[132:135]
ds_read_b128 v[96:99], v110 offset:62464
s_sub_u32 s1, s0, 43
v_mfma_f32_16x16x32_bf16 v[136:139], v[204:207], v[64:67], v[136:139]
ds_read_b128 v[100:103], v110 offset:64512
s_cmp_lt_u32 s0, 43
v_mfma_f32_16x16x32_bf16 v[140:143], v[204:207], v[68:71], v[140:143]
ds_read_b64_tr_b16 v[228:229], v109 offset:4096
v_mfma_f32_16x16x32_bf16 v[176:179], v[204:207], v[20:23], v[176:179]
ds_read_b64_tr_b16 v[230:231], v109 offset:6144
s_cselect_b32 s0, s0, s1
v_mfma_f32_16x16x32_bf16 v[144:147], v[208:211], v[56:59], v[144:147]
s_lshl_b32 s0, s0, 15
v_mfma_f32_16x16x32_bf16 v[148:151], v[208:211], v[60:63], v[148:151]
ds_read_b64_tr_b16 v[232:233], v109 offset:12288
v_mfma_f32_16x16x32_bf16 v[152:155], v[208:211], v[64:67], v[152:155]
ds_read_b64_tr_b16 v[234:235], v109 offset:14336
s_add_u32 m0, s98, 16384
v_mfma_f32_16x16x32_bf16 v[156:159], v[208:211], v[68:71], v[156:159]
ds_read_b64_tr_b16 v[236:237], v109 offset:20480
v_mfma_f32_16x16x32_bf16 v[180:183], v[208:211], v[20:23], v[180:183]
ds_read_b64_tr_b16 v[238:239], v109 offset:22528
buffer_load_dwordx4 v8, s[36:39], s0 offen offset:0 lds
v_mfma_f32_16x16x32_bf16 v[160:163], v[212:215], v[56:59], v[160:163]
buffer_load_dwordx4 v10, s[36:39], s0 offen offset:1024 lds
v_mfma_f32_16x16x32_bf16 v[164:167], v[212:215], v[60:63], v[164:167]
v_mfma_f32_16x16x32_bf16 v[168:171], v[212:215], v[64:67], v[168:171]
buffer_load_dwordx4 v11, s[36:39], s0 offen offset:2048 lds
v_mfma_f32_16x16x32_bf16 v[172:175], v[212:215], v[68:71], v[172:175]
buffer_load_dwordx4 v255, s[36:39], s0 offen offset:3072 lds
v_mfma_f32_16x16x32_bf16 v[184:187], v[212:215], v[20:23], v[184:187]
s_waitcnt vmcnt(12)
s_barrier
s_waitcnt lgkmcnt(0)
v_mfma_f32_16x16x32_bf16 v[128:131], v[216:219], v[72:75], v[128:131]
v_mfma_f32_16x16x32_bf16 v[132:135], v[216:219], v[76:79], v[132:135]
ds_read_b128 v[40:43], v1 offset:0
v_mfma_f32_16x16x32_bf16 v[136:139], v[216:219], v[80:83], v[136:139]
ds_read_b128 v[44:47], v1 offset:2048
v_mfma_f32_16x16x32_bf16 v[140:143], v[216:219], v[84:87], v[140:143]
ds_read_b128 v[48:51], v1 offset:4096
v_mfma_f32_16x16x32_bf16 v[176:179], v[216:219], v[20:23], v[176:179]
ds_read_b128 v[52:55], v1 offset:6144
v_mfma_f32_16x16x32_bf16 v[144:147], v[220:223], v[72:75], v[144:147]
v_mfma_f32_16x16x32_bf16 v[148:151], v[220:223], v[76:79], v[148:151]
ds_read_b64_tr_b16 v[192:193], v109 offset:24576
v_mfma_f32_16x16x32_bf16 v[152:155], v[220:223], v[80:83], v[152:155]
ds_read_b64_tr_b16 v[194:195], v109 offset:26624
v_mfma_f32_16x16x32_bf16 v[156:159], v[220:223], v[84:87], v[156:159]
ds_read_b64_tr_b16 v[196:197], v109 offset:32768
v_mfma_f32_16x16x32_bf16 v[180:183], v[220:223], v[20:23], v[180:183]
ds_read_b64_tr_b16 v[198:199], v109 offset:34816
v_mfma_f32_16x16x32_bf16 v[160:163], v[224:227], v[72:75], v[160:163]
v_mfma_f32_16x16x32_bf16 v[164:167], v[224:227], v[76:79], v[164:167]
ds_read_b64_tr_b16 v[200:201], v109 offset:40960
v_mfma_f32_16x16x32_bf16 v[168:171], v[224:227], v[80:83], v[168:171]
ds_read_b64_tr_b16 v[202:203], v109 offset:43008
v_mfma_f32_16x16x32_bf16 v[172:175], v[224:227], v[84:87], v[172:175]
ds_read_b128 v[56:59], v1 offset:1024
v_mfma_f32_16x16x32_bf16 v[184:187], v[224:227], v[20:23], v[184:187]
ds_read_b128 v[60:63], v1 offset:3072
v_mfma_f32_16x16x32_bf16 v[128:131], v[228:231], v[88:91], v[128:131]
v_mfma_f32_16x16x32_bf16 v[132:135], v[228:231], v[92:95], v[132:135]
ds_read_b128 v[64:67], v1 offset:5120
v_mfma_f32_16x16x32_bf16 v[136:139], v[228:231], v[96:99], v[136:139]
ds_read_b128 v[68:71], v1 offset:7168
v_mfma_f32_16x16x32_bf16 v[140:143], v[228:231], v[100:103], v[140:143]
ds_read_b64_tr_b16 v[204:205], v109 offset:28672
v_mfma_f32_16x16x32_bf16 v[176:179], v[228:231], v[20:23], v[176:179]
ds_read_b64_tr_b16 v[206:207], v109 offset:30720
v_mfma_f32_16x16x32_bf16 v[144:147], v[232:235], v[88:91], v[144:147]
v_mfma_f32_16x16x32_bf16 v[148:151], v[232:235], v[92:95], v[148:151]
ds_read_b64_tr_b16 v[208:209], v109 offset:36864
v_mfma_f32_16x16x32_bf16 v[152:155], v[232:235], v[96:99], v[152:155]
ds_read_b64_tr_b16 v[210:211], v109 offset:38912
v_mfma_f32_16x16x32_bf16 v[156:159], v[232:235], v[100:103], v[156:159]
ds_read_b64_tr_b16 v[212:213], v109 offset:45056
v_mfma_f32_16x16x32_bf16 v[180:183], v[232:235], v[20:23], v[180:183]
ds_read_b64_tr_b16 v[214:215], v109 offset:47104
v_mfma_f32_16x16x32_bf16 v[160:163], v[236:239], v[88:91], v[160:163]
v_mfma_f32_16x16x32_bf16 v[164:167], v[236:239], v[92:95], v[164:167]
v_mfma_f32_16x16x32_bf16 v[168:171], v[236:239], v[96:99], v[168:171]
v_mfma_f32_16x16x32_bf16 v[172:175], v[236:239], v[100:103], v[172:175]
v_mfma_f32_16x16x32_bf16 v[184:187], v[236:239], v[20:23], v[184:187]
s_waitcnt vmcnt(4)
s_barrier
s_waitcnt lgkmcnt(0)
v_mfma_f32_16x16x32_bf16 v[128:131], v[192:195], v[40:43], v[128:131]
v_mfma_f32_16x16x32_bf16 v[132:135], v[192:195], v[44:47], v[132:135]
ds_read_b128 v[72:75], v1 offset:8192
v_mfma_f32_16x16x32_bf16 v[136:139], v[192:195], v[48:51], v[136:139]
ds_read_b128 v[76:79], v1 offset:10240
s_add_u32 s0, s89, 4
v_mfma_f32_16x16x32_bf16 v[140:143], v[192:195], v[52:55], v[140:143]
ds_read_b128 v[80:83], v1 offset:12288
v_mfma_f32_16x16x32_bf16 v[176:179], v[192:195], v[20:23], v[176:179]
ds_read_b128 v[84:87], v1 offset:14336
v_mfma_f32_16x16x32_bf16 v[144:147], v[196:199], v[40:43], v[144:147]
s_sub_u32 s1, s0, 43
v_mfma_f32_16x16x32_bf16 v[148:151], v[196:199], v[44:47], v[148:151]
ds_read_b64_tr_b16 v[216:217], v111 offset:0
v_mfma_f32_16x16x32_bf16 v[152:155], v[196:199], v[48:51], v[152:155]
ds_read_b64_tr_b16 v[218:219], v111 offset:2048
v_mfma_f32_16x16x32_bf16 v[156:159], v[196:199], v[52:55], v[156:159]
ds_read_b64_tr_b16 v[220:221], v111 offset:8192
s_cmp_lt_u32 s0, 43
v_mfma_f32_16x16x32_bf16 v[180:183], v[196:199], v[20:23], v[180:183]
ds_read_b64_tr_b16 v[222:223], v111 offset:10240
v_mfma_f32_16x16x32_bf16 v[160:163], v[200:203], v[40:43], v[160:163]
v_mfma_f32_16x16x32_bf16 v[164:167], v[200:203], v[44:47], v[164:167]
ds_read_b64_tr_b16 v[224:225], v111 offset:16384
s_cselect_b32 s0, s0, s1
v_mfma_f32_16x16x32_bf16 v[168:171], v[200:203], v[48:51], v[168:171]
ds_read_b64_tr_b16 v[226:227], v111 offset:18432
v_mfma_f32_16x16x32_bf16 v[172:175], v[200:203], v[52:55], v[172:175]
ds_read_b128 v[88:91], v1 offset:9216
v_mfma_f32_16x16x32_bf16 v[184:187], v[200:203], v[20:23], v[184:187]
ds_read_b128 v[92:95], v1 offset:11264
s_lshl_b32 s0, s0, 15
v_mfma_f32_16x16x32_bf16 v[128:131], v[204:207], v[56:59], v[128:131]
v_mfma_f32_16x16x32_bf16 v[132:135], v[204:207], v[60:63], v[132:135]
ds_read_b128 v[96:99], v1 offset:13312
v_mfma_f32_16x16x32_bf16 v[136:139], v[204:207], v[64:67], v[136:139]
ds_read_b128 v[100:103], v1 offset:15360
s_add_u32 m0, s98, 32768
v_mfma_f32_16x16x32_bf16 v[140:143], v[204:207], v[68:71], v[140:143]
ds_read_b64_tr_b16 v[228:229], v111 offset:4096
v_mfma_f32_16x16x32_bf16 v[176:179], v[204:207], v[20:23], v[176:179]
ds_read_b64_tr_b16 v[230:231], v111 offset:6144
v_mfma_f32_16x16x32_bf16 v[144:147], v[208:211], v[56:59], v[144:147]
buffer_load_dwordx4 v8, s[36:39], s0 offen offset:0 lds
v_mfma_f32_16x16x32_bf16 v[148:151], v[208:211], v[60:63], v[148:151]
ds_read_b64_tr_b16 v[232:233], v111 offset:12288
v_mfma_f32_16x16x32_bf16 v[152:155], v[208:211], v[64:67], v[152:155]
ds_read_b64_tr_b16 v[234:235], v111 offset:14336
v_mfma_f32_16x16x32_bf16 v[156:159], v[208:211], v[68:71], v[156:159]
ds_read_b64_tr_b16 v[236:237], v111 offset:20480
buffer_load_dwordx4 v10, s[36:39], s0 offen offset:1024 lds
v_mfma_f32_16x16x32_bf16 v[180:183], v[208:211], v[20:23], v[180:183]
ds_read_b64_tr_b16 v[238:239], v111 offset:22528
v_mfma_f32_16x16x32_bf16 v[160:163], v[212:215], v[56:59], v[160:163]
v_mfma_f32_16x16x32_bf16 v[164:167], v[212:215], v[60:63], v[164:167]
buffer_load_dwordx4 v11, s[36:39], s0 offen offset:2048 lds
v_mfma_f32_16x16x32_bf16 v[168:171], v[212:215], v[64:67], v[168:171]
v_mfma_f32_16x16x32_bf16 v[172:175], v[212:215], v[68:71], v[172:175]
buffer_load_dwordx4 v255, s[36:39], s0 offen offset:3072 lds
v_mfma_f32_16x16x32_bf16 v[184:187], v[212:215], v[20:23], v[184:187]
s_barrier
s_waitcnt lgkmcnt(0)
v_mfma_f32_16x16x32_bf16 v[128:131], v[216:219], v[72:75], v[128:131]
ds_read_b128 v[192:195], v104 offset:0
v_mfma_f32_16x16x32_bf16 v[132:135], v[216:219], v[76:79], v[132:135]
ds_read_b128 v[196:199], v104 offset:256
v_mfma_f32_16x16x32_bf16 v[136:139], v[216:219], v[80:83], v[136:139]
s_add_u32 s0, s89, 8
ds_read_b128 v[200:203], v104 offset:512
v_mfma_f32_16x16x32_bf16 v[140:143], v[216:219], v[84:87], v[140:143]
ds_read_b128 v[204:207], v104 offset:768
v_mfma_f32_16x16x32_bf16 v[176:179], v[216:219], v[20:23], v[176:179]
v_mfma_f32_16x16x32_bf16 v[144:147], v[220:223], v[72:75], v[144:147]
s_sub_u32 s1, s0, 43
v_mfma_f32_16x16x32_bf16 v[148:151], v[220:223], v[76:79], v[148:151]
v_mfma_f32_16x16x32_bf16 v[152:155], v[220:223], v[80:83], v[152:155]
v_mfma_f32_16x16x32_bf16 v[156:159], v[220:223], v[84:87], v[156:159]
s_cmp_lt_u32 s0, 43
v_mfma_f32_16x16x32_bf16 v[180:183], v[220:223], v[20:23], v[180:183]
v_mfma_f32_16x16x32_bf16 v[160:163], v[224:227], v[72:75], v[160:163]
v_mfma_f32_16x16x32_bf16 v[164:167], v[224:227], v[76:79], v[164:167]
s_cselect_b32 s0, s0, s1
v_mfma_f32_16x16x32_bf16 v[168:171], v[224:227], v[80:83], v[168:171]
v_mfma_f32_16x16x32_bf16 v[172:175], v[224:227], v[84:87], v[172:175]
v_mfma_f32_16x16x32_bf16 v[184:187], v[224:227], v[20:23], v[184:187]
s_lshl_b32 s0, s0, 15
v_mfma_f32_16x16x32_bf16 v[128:131], v[228:231], v[88:91], v[128:131]
v_mfma_f32_16x16x32_bf16 v[132:135], v[228:231], v[92:95], v[132:135]
v_mfma_f32_16x16x32_bf16 v[136:139], v[228:231], v[96:99], v[136:139]
s_add_u32 m0, s98, 49152
v_mfma_f32_16x16x32_bf16 v[140:143], v[228:231], v[100:103], v[140:143]
v_mfma_f32_16x16x32_bf16 v[176:179], v[228:231], v[20:23], v[176:179]
v_mfma_f32_16x16x32_bf16 v[144:147], v[232:235], v[88:91], v[144:147]
buffer_load_dwordx4 v8, s[36:39], s0 offen offset:0 lds
v_mfma_f32_16x16x32_bf16 v[148:151], v[232:235], v[92:95], v[148:151]
v_mfma_f32_16x16x32_bf16 v[152:155], v[232:235], v[96:99], v[152:155]
v_mfma_f32_16x16x32_bf16 v[156:159], v[232:235], v[100:103], v[156:159]
buffer_load_dwordx4 v10, s[36:39], s0 offen offset:1024 lds
v_mfma_f32_16x16x32_bf16 v[180:183], v[232:235], v[20:23], v[180:183]
v_mfma_f32_16x16x32_bf16 v[160:163], v[236:239], v[88:91], v[160:163]
v_mfma_f32_16x16x32_bf16 v[164:167], v[236:239], v[92:95], v[164:167]
buffer_load_dwordx4 v11, s[36:39], s0 offen offset:2048 lds
v_mfma_f32_16x16x32_bf16 v[168:171], v[236:239], v[96:99], v[168:171]
v_mfma_f32_16x16x32_bf16 v[172:175], v[236:239], v[100:103], v[172:175]
buffer_load_dwordx4 v255, s[36:39], s0 offen offset:3072 lds
v_mfma_f32_16x16x32_bf16 v[184:187], v[236:239], v[20:23], v[184:187]
s_barrier
s_waitcnt lgkmcnt(0)
s_nop 0
v_pk_fma_f32 v[128:129], v[176:177], v[192:193], v[128:129] neg_lo:[1,0,0] neg_hi:[1,0,0]
v_pk_fma_f32 v[130:131], v[178:179], v[192:193], v[130:131] neg_lo:[1,0,0] neg_hi:[1,0,0]
v_pk_fma_f32 v[132:133], v[176:177], v[196:197], v[132:133] neg_lo:[1,0,0] neg_hi:[1,0,0]
v_pk_fma_f32 v[134:135], v[178:179], v[196:197], v[134:135] neg_lo:[1,0,0] neg_hi:[1,0,0]
v_pk_fma_f32 v[136:137], v[176:177], v[200:201], v[136:137] neg_lo:[1,0,0] neg_hi:[1,0,0]
v_pk_fma_f32 v[138:139], v[178:179], v[200:201], v[138:139] neg_lo:[1,0,0] neg_hi:[1,0,0]
s_add_u32 s0, s89, 12
s_nop 0
v_pk_fma_f32 v[140:141], v[176:177], v[204:205], v[140:141] neg_lo:[1,0,0] neg_hi:[1,0,0]
v_pk_fma_f32 v[142:143], v[178:179], v[204:205], v[142:143] neg_lo:[1,0,0] neg_hi:[1,0,0]
v_pk_mul_f32 v[128:129], v[128:129], v[194:195]
v_pk_mul_f32 v[130:131], v[130:131], v[194:195]
v_pk_mul_f32 v[132:133], v[132:133], v[198:199]
v_pk_mul_f32 v[134:135], v[134:135], v[198:199]
s_sub_u32 s1, s0, 43
s_nop 0
v_pk_mul_f32 v[136:137], v[136:137], v[202:203]
v_pk_mul_f32 v[138:139], v[138:139], v[202:203]
v_pk_mul_f32 v[140:141], v[140:141], v[206:207]
v_pk_mul_f32 v[142:143], v[142:143], v[206:207]
v_pk_mul_f32 v[40:41], v[128:129], v[128:129]
v_pk_mul_f32 v[42:43], v[130:131], v[130:131]
s_cmp_lt_u32 s0, 43
s_nop 0
v_pk_mul_f32 v[44:45], v[132:133], v[132:133]
v_pk_mul_f32 v[46:47], v[134:135], v[134:135]
v_pk_mul_f32 v[48:49], v[136:137], v[136:137]
v_pk_mul_f32 v[50:51], v[138:139], v[138:139]
v_pk_mul_f32 v[52:53], v[140:141], v[140:141]
s_cselect_b32 s0, s0, s1
s_nop 0
v_pk_mul_f32 v[54:55], v[142:143], v[142:143]
v_pk_fma_f32 v[40:41], v[40:41], s[80:81], s[80:81] op_sel:[0,1,0] op_sel_hi:[1,1,0]
v_pk_fma_f32 v[42:43], v[42:43], s[80:81], s[80:81] op_sel:[0,1,0] op_sel_hi:[1,1,0]
v_pk_fma_f32 v[44:45], v[44:45], s[80:81], s[80:81] op_sel:[0,1,0] op_sel_hi:[1,1,0]
v_pk_fma_f32 v[46:47], v[46:47], s[80:81], s[80:81] op_sel:[0,1,0] op_sel_hi:[1,1,0]
v_pk_fma_f32 v[48:49], v[48:49], s[80:81], s[80:81] op_sel:[0,1,0] op_sel_hi:[1,1,0]
s_lshl_b32 s0, s0, 15
s_nop 0
v_pk_fma_f32 v[50:51], v[50:51], s[80:81], s[80:81] op_sel:[0,1,0] op_sel_hi:[1,1,0]
v_pk_fma_f32 v[52:53], v[52:53], s[80:81], s[80:81] op_sel:[0,1,0] op_sel_hi:[1,1,0]
v_pk_fma_f32 v[54:55], v[54:55], s[80:81], s[80:81] op_sel:[0,1,0] op_sel_hi:[1,1,0]
v_pk_mul_f32 v[40:41], v[40:41], v[128:129]
v_pk_mul_f32 v[42:43], v[42:43], v[130:131]
v_pk_mul_f32 v[44:45], v[44:45], v[132:133]
s_add_u32 m0, s98, 65536
v_pk_mul_f32 v[46:47], v[46:47], v[134:135]
v_pk_mul_f32 v[48:49], v[48:49], v[136:137]
v_pk_mul_f32 v[50:51], v[50:51], v[138:139]
v_pk_mul_f32 v[52:53], v[52:53], v[140:141]
v_pk_mul_f32 v[54:55], v[54:55], v[142:143]
buffer_load_dwordx4 v8, s[36:39], s0 offen offset:0 lds
v_exp_f32 v40, v40
v_exp_f32 v41, v41
v_exp_f32 v42, v42
v_exp_f32 v43, v43
v_exp_f32 v44, v44
v_exp_f32 v45, v45
s_branch Lpg_7_n
.p2align 12
Lpg_7:
s_setpc_b64 s[100:101]
s_nop 0
Lpg_7_n:
buffer_load_dwordx4 v10, s[36:39], s0 offen offset:1024 lds
v_exp_f32 v46, v46
v_exp_f32 v47, v47
v_exp_f32 v48, v48
v_exp_f32 v49, v49
v_exp_f32 v50, v50
v_exp_f32 v51, v51
buffer_load_dwordx4 v11, s[36:39], s0 offen offset:2048 lds
v_exp_f32 v52, v52
v_exp_f32 v53, v53
v_exp_f32 v54, v54
v_exp_f32 v55, v55
v_pk_add_f32 v[40:41], v[40:41], s[94:95]
v_pk_add_f32 v[42:43], v[42:43], s[94:95]
buffer_load_dwordx4 v255, s[36:39], s0 offen offset:3072 lds
v_pk_add_f32 v[44:45], v[44:45], s[94:95]
v_pk_add_f32 v[46:47], v[46:47], s[94:95]
v_pk_add_f32 v[48:49], v[48:49], s[94:95]
v_pk_add_f32 v[50:51], v[50:51], s[94:95]
v_pk_add_f32 v[52:53], v[52:53], s[94:95]
s_add_u32 s0, s89, 16
v_pk_add_f32 v[54:55], v[54:55], s[94:95]
v_rcp_f32 v40, v40
v_rcp_f32 v41, v41
v_rcp_f32 v42, v42
v_rcp_f32 v43, v43
v_rcp_f32 v44, v44
s_sub_u32 s1, s0, 43
v_rcp_f32 v45, v45
v_rcp_f32 v46, v46
v_rcp_f32 v47, v47
v_rcp_f32 v48, v48
v_rcp_f32 v49, v49
v_rcp_f32 v50, v50
s_cmp_lt_u32 s0, 43
v_rcp_f32 v51, v51
v_rcp_f32 v52, v52
v_rcp_f32 v53, v53
v_rcp_f32 v54, v54
v_rcp_f32 v55, v55
s_cselect_b32 s0, s0, s1
v_pk_mul_f32 v[128:129], v[128:129], v[40:41]
v_pk_mul_f32 v[130:131], v[130:131], v[42:43]
v_pk_mul_f32 v[132:133], v[132:133], v[44:45]
v_pk_mul_f32 v[134:135], v[134:135], v[46:47]
v_pk_mul_f32 v[136:137], v[136:137], v[48:49]
v_pk_mul_f32 v[138:139], v[138:139], v[50:51]
s_lshl_b32 s0, s0, 15
s_nop 0
v_pk_mul_f32 v[140:141], v[140:141], v[52:53]
v_pk_mul_f32 v[142:143], v[142:143], v[54:55]
v_cvt_pk_bf16_f32 v72, v128, v129
v_cvt_pk_bf16_f32 v73, v130, v131
v_cvt_pk_bf16_f32 v74, v132, v133
v_cvt_pk_bf16_f32 v75, v134, v135
s_add_u32 m0, s98, 81920
v_cvt_pk_bf16_f32 v76, v136, v137
v_cvt_pk_bf16_f32 v77, v138, v139
v_cvt_pk_bf16_f32 v78, v140, v141
v_cvt_pk_bf16_f32 v79, v142, v143
ds_write_b64 v116, v[72:73] offset:0
buffer_load_dwordx4 v8, s[36:39], s0 offen offset:0 lds
ds_write_b64 v116, v[74:75] offset:6144
ds_write_b64 v116, v[76:77] offset:12288
ds_write_b64 v116, v[78:79] offset:18432
v_pk_fma_f32 v[144:145], v[180:181], v[192:193], v[144:145] neg_lo:[1,0,0] neg_hi:[1,0,0]
v_pk_fma_f32 v[146:147], v[182:183], v[192:193], v[146:147] neg_lo:[1,0,0] neg_hi:[1,0,0]
v_pk_fma_f32 v[148:149], v[180:181], v[196:197], v[148:149] neg_lo:[1,0,0] neg_hi:[1,0,0]
buffer_load_dwordx4 v10, s[36:39], s0 offen offset:1024 lds
v_pk_fma_f32 v[150:151], v[182:183], v[196:197], v[150:151] neg_lo:[1,0,0] neg_hi:[1,0,0]
v_pk_fma_f32 v[152:153], v[180:181], v[200:201], v[152:153] neg_lo:[1,0,0] neg_hi:[1,0,0]
v_pk_fma_f32 v[154:155], v[182:183], v[200:201], v[154:155] neg_lo:[1,0,0] neg_hi:[1,0,0]
v_pk_fma_f32 v[156:157], v[180:181], v[204:205], v[156:157] neg_lo:[1,0,0] neg_hi:[1,0,0]
v_pk_fma_f32 v[158:159], v[182:183], v[204:205], v[158:159] neg_lo:[1,0,0] neg_hi:[1,0,0]
v_pk_mul_f32 v[144:145], v[144:145], v[194:195]
buffer_load_dwordx4 v11, s[36:39], s0 offen offset:2048 lds
v_pk_mul_f32 v[146:147], v[146:147], v[194:195]
v_pk_mul_f32 v[148:149], v[148:149], v[198:199]
v_pk_mul_f32 v[150:151], v[150:151], v[198:199]
v_pk_mul_f32 v[152:153], v[152:153], v[202:203]
v_pk_mul_f32 v[154:155], v[154:155], v[202:203]
v_pk_mul_f32 v[156:157], v[156:157], v[206:207]
buffer_load_dwordx4 v255, s[36:39], s0 offen offset:3072 lds
v_pk_mul_f32 v[158:159], v[158:159], v[206:207]
v_pk_mul_f32 v[40:41], v[144:145], v[144:145]
v_pk_mul_f32 v[42:43], v[146:147], v[146:147]
v_pk_mul_f32 v[44:45], v[148:149], v[148:149]
v_pk_mul_f32 v[46:47], v[150:151], v[150:151]
s_add_u32 s0, s89, 20
s_nop 0
v_pk_mul_f32 v[48:49], v[152:153], v[152:153]
v_pk_mul_f32 v[50:51], v[154:155], v[154:155]
v_pk_mul_f32 v[52:53], v[156:157], v[156:157]
v_pk_mul_f32 v[54:55], v[158:159], v[158:159]
v_pk_fma_f32 v[40:41], v[40:41], s[80:81], s[80:81] op_sel:[0,1,0] op_sel_hi:[1,1,0]
v_pk_fma_f32 v[42:43], v[42:43], s[80:81], s[80:81] op_sel:[0,1,0] op_sel_hi:[1,1,0]
s_sub_u32 s1, s0, 43
s_nop 0
v_pk_fma_f32 v[44:45], v[44:45], s[80:81], s[80:81] op_sel:[0,1,0] op_sel_hi:[1,1,0]
v_pk_fma_f32 v[46:47], v[46:47], s[80:81], s[80:81] op_sel:[0,1,0] op_sel_hi:[1,1,0]
v_pk_fma_f32 v[48:49], v[48:49], s[80:81], s[80:81] op_sel:[0,1,0] op_sel_hi:[1,1,0]
v_pk_fma_f32 v[50:51], v[50:51], s[80:81], s[80:81] op_sel:[0,1,0] op_sel_hi:[1,1,0]
v_pk_fma_f32 v[52:53], v[52:53], s[80:81], s[80:81] op_sel:[0,1,0] op_sel_hi:[1,1,0]
v_pk_fma_f32 v[54:55], v[54:55], s[80:81], s[80:81] op_sel:[0,1,0] op_sel_hi:[1,1,0]
s_cmp_lt_u32 s0, 43
s_nop 0
v_pk_mul_f32 v[40:41], v[40:41], v[144:145]
v_pk_mul_f32 v[42:43], v[42:43], v[146:147]
v_pk_mul_f32 v[44:45], v[44:45], v[148:149]
v_pk_mul_f32 v[46:47], v[46:47], v[150:151]
v_pk_mul_f32 v[48:49], v[48:49], v[152:153]
s_cselect_b32 s0, s0, s1
s_nop 0
v_pk_mul_f32 v[50:51], v[50:51], v[154:155]
v_pk_mul_f32 v[52:53], v[52:53], v[156:157]
v_pk_mul_f32 v[54:55], v[54:55], v[158:159]
v_exp_f32 v40, v40
v_exp_f32 v41, v41
v_exp_f32 v42, v42
s_lshl_b32 s0, s0, 15
v_exp_f32 v43, v43
v_exp_f32 v44, v44
v_exp_f32 v45, v45
v_exp_f32 v46, v46
v_exp_f32 v47, v47
v_exp_f32 v48, v48
s_add_u32 m0, s98, 98304
v_exp_f32 v49, v49
v_exp_f32 v50, v50
v_exp_f32 v51, v51
v_exp_f32 v52, v52
v_exp_f32_e64 v53, v53
buffer_load_dwordx4 v8, s[36:39], s0 offen offset:0 lds
v_exp_f32 v54, v54
v_exp_f32 v55, v55
v_pk_add_f32 v[40:41], v[40:41], s[94:95]
v_pk_add_f32 v[42:43], v[42:43], s[94:95]
v_pk_add_f32 v[44:45], v[44:45], s[94:95]
v_pk_add_f32 v[46:47], v[46:47], s[94:95]
buffer_load_dwordx4 v10, s[36:39], s0 offen offset:1024 lds
v_pk_add_f32 v[48:49], v[48:49], s[94:95]
v_pk_add_f32 v[50:51], v[50:51], s[94:95]
v_pk_add_f32 v[52:53], v[52:53], s[94:95]
v_pk_add_f32 v[54:55], v[54:55], s[94:95]
v_rcp_f32 v40, v40
v_rcp_f32 v41, v41
buffer_load_dwordx4 v11, s[36:39], s0 offen offset:2048 lds
v_rcp_f32 v42, v42
v_rcp_f32 v43, v43
v_rcp_f32 v44, v44
v_rcp_f32 v45, v45
v_rcp_f32 v46, v46
v_rcp_f32 v47, v47
buffer_load_dwordx4 v255, s[36:39], s0 offen offset:3072 lds
v_rcp_f32 v48, v48
v_rcp_f32 v49, v49
v_rcp_f32 v50, v50
v_rcp_f32 v51, v51
v_rcp_f32 v52, v52
s_add_u32 s0, s89, 24
v_rcp_f32 v53, v53
v_rcp_f32 v54, v54
v_rcp_f32_e64 v55, v55
v_pk_mul_f32 v[144:145], v[144:145], v[40:41]
v_pk_mul_f32 v[146:147], v[146:147], v[42:43]
v_pk_mul_f32 v[148:149], v[148:149], v[44:45]
s_sub_u32 s1, s0, 43
s_nop 0
v_pk_mul_f32 v[150:151], v[150:151], v[46:47]
v_pk_mul_f32 v[152:153], v[152:153], v[48:49]
v_pk_mul_f32 v[154:155], v[154:155], v[50:51]
v_pk_mul_f32 v[156:157], v[156:157], v[52:53]
v_pk_mul_f32 v[158:159], v[158:159], v[54:55]
v_cvt_pk_bf16_f32 v80, v144, v145
s_cmp_lt_u32 s0, 43
s_nop 0
v_cvt_pk_bf16_f32 v81, v146, v147
v_cvt_pk_bf16_f32 v82, v148, v149
v_cvt_pk_bf16_f32 v83, v150, v151
v_cvt_pk_bf16_f32 v84, v152, v153
v_cvt_pk_bf16_f32 v85, v154, v155
s_cselect_b32 s0, s0, s1
s_nop 0
v_cvt_pk_bf16_f32 v86, v156, v157
v_cvt_pk_bf16_f32 v87, v158, v159
ds_write_b64 v116, v[80:81] offset:2048
ds_write_b64 v116, v[82:83] offset:8192
ds_write_b64 v116, v[84:85] offset:14336
ds_write_b64 v116, v[86:87] offset:20480
s_lshl_b32 s0, s0, 15
s_nop 0
v_pk_fma_f32 v[160:161], v[184:185], v[192:193], v[160:161] neg_lo:[1,0,0] neg_hi:[1,0,0]
v_pk_fma_f32 v[162:163], v[186:187], v[192:193], v[162:163] neg_lo:[1,0,0] neg_hi:[1,0,0]
v_pk_fma_f32 v[164:165], v[184:185], v[196:197], v[164:165] neg_lo:[1,0,0] neg_hi:[1,0,0]
v_pk_fma_f32 v[166:167], v[186:187], v[196:197], v[166:167] neg_lo:[1,0,0] neg_hi:[1,0,0]
v_pk_fma_f32 v[168:169], v[184:185], v[200:201], v[168:169] neg_lo:[1,0,0] neg_hi:[1,0,0]
v_pk_fma_f32 v[170:171], v[186:187], v[200:201], v[170:171] neg_lo:[1,0,0] neg_hi:[1,0,0]
s_add_u32 m0, s98, 114688
v_pk_fma_f32 v[172:173], v[184:185], v[204:205], v[172:173] neg_lo:[1,0,0] neg_hi:[1,0,0]
v_pk_fma_f32 v[174:175], v[186:187], v[204:205], v[174:175] neg_lo:[1,0,0] neg_hi:[1,0,0]
v_pk_mul_f32 v[160:161], v[160:161], v[194:195]
v_pk_mul_f32 v[162:163], v[162:163], v[194:195]
v_pk_mul_f32 v[164:165], v[164:165], v[198:199]
buffer_load_dwordx4 v8, s[36:39], s0 offen offset:0 lds
v_pk_mul_f32 v[166:167], v[166:167], v[198:199]
v_pk_mul_f32 v[168:169], v[168:169], v[202:203]
v_pk_mul_f32 v[170:171], v[170:171], v[202:203]
v_pk_mul_f32 v[172:173], v[172:173], v[206:207]
v_pk_mul_f32 v[174:175], v[174:175], v[206:207]
v_pk_mul_f32 v[40:41], v[160:161], v[160:161]
buffer_load_dwordx4 v10, s[36:39], s0 offen offset:1024 lds
v_pk_mul_f32 v[42:43], v[162:163], v[162:163]
v_pk_mul_f32 v[44:45], v[164:165], v[164:165]
v_pk_mul_f32 v[46:47], v[166:167], v[166:167]
v_pk_mul_f32 v[48:49], v[168:169], v[168:169]
v_pk_mul_f32 v[50:51], v[170:171], v[170:171]
v_pk_mul_f32 v[52:53], v[172:173], v[172:173]
buffer_load_dwordx4 v11, s[36:39], s0 offen offset:2048 lds
v_pk_mul_f32 v[54:55], v[174:175], v[174:175]
v_pk_fma_f32 v[40:41], v[40:41], s[80:81], s[80:81] op_sel:[0,1,0] op_sel_hi:[1,1,0]
v_pk_fma_f32 v[42:43], v[42:43], s[80:81], s[80:81] op_sel:[0,1,0] op_sel_hi:[1,1,0]
v_pk_fma_f32 v[44:45], v[44:45], s[80:81], s[80:81] op_sel:[0,1,0] op_sel_hi:[1,1,0]
v_pk_fma_f32 v[46:47], v[46:47], s[80:81], s[80:81] op_sel:[0,1,0] op_sel_hi:[1,1,0]
v_pk_fma_f32 v[48:49], v[48:49], s[80:81], s[80:81] op_sel:[0,1,0] op_sel_hi:[1,1,0]
buffer_load_dwordx4 v255, s[36:39], s0 offen offset:3072 lds
v_pk_fma_f32 v[50:51], v[50:51], s[80:81], s[80:81] op_sel:[0,1,0] op_sel_hi:[1,1,0]
v_pk_fma_f32 v[52:53], v[52:53], s[80:81], s[80:81] op_sel:[0,1,0] op_sel_hi:[1,1,0]
v_pk_fma_f32 v[54:55], v[54:55], s[80:81], s[80:81] op_sel:[0,1,0] op_sel_hi:[1,1,0]
v_pk_mul_f32 v[40:41], v[40:41], v[160:161]
v_pk_mul_f32 v[42:43], v[42:43], v[162:163]
s_add_u32 s0, s89, 28
s_nop 0
v_pk_mul_f32 v[44:45], v[44:45], v[164:165]
v_pk_mul_f32 v[46:47], v[46:47], v[166:167]
v_pk_mul_f32 v[48:49], v[48:49], v[168:169]
v_pk_mul_f32 v[50:51], v[50:51], v[170:171]
v_pk_mul_f32 v[52:53], v[52:53], v[172:173]
v_pk_mul_f32 v[54:55], v[54:55], v[174:175]
s_sub_u32 s1, s0, 43
v_exp_f32 v40, v40
v_exp_f32 v41, v41
v_exp_f32 v42, v42
v_exp_f32 v43, v43
v_exp_f32 v44, v44
v_exp_f32 v45, v45
s_cmp_lt_u32 s0, 43
v_exp_f32 v46, v46
v_exp_f32 v47, v47
v_exp_f32 v48, v48
v_exp_f32 v49, v49
v_exp_f32 v50, v50
s_cselect_b32 s0, s0, s1
v_exp_f32 v51, v51
v_exp_f32 v52, v52
v_exp_f32 v53, v53
v_exp_f32 v54, v54
v_exp_f32_e64 v55, v55
v_pk_add_f32 v[40:41], v[40:41], s[94:95]
s_lshl_b32 s0, s0, 15
s_nop 0
v_pk_add_f32 v[42:43], v[42:43], s[94:95]
v_pk_add_f32 v[44:45], v[44:45], s[94:95]
v_pk_add_f32 v[46:47], v[46:47], s[94:95]
v_pk_add_f32 v[48:49], v[48:49], s[94:95]
v_pk_add_f32 v[50:51], v[50:51], s[94:95]
v_pk_add_f32 v[52:53], v[52:53], s[94:95]
s_add_u32 m0, s98, 0
v_pk_add_f32 v[54:55], v[54:55], s[94:95]
v_rcp_f32 v40, v40
v_rcp_f32 v41, v41
v_rcp_f32 v42, v42
v_rcp_f32_e64 v43, v43
buffer_load_dwordx4 v8, s[36:39], s0 offen offset:0 lds
v_rcp_f32 v44, v44
v_rcp_f32 v45, v45
v_rcp_f32 v46, v46
v_rcp_f32 v47, v47
v_rcp_f32 v48, v48
v_rcp_f32 v49, v49
buffer_load_dwordx4 v10, s[36:39], s0 offen offset:1024 lds
v_rcp_f32 v50, v50
v_rcp_f32 v51, v51
v_rcp_f32 v52, v52
v_rcp_f32 v53, v53
v_rcp_f32 v54, v54
v_rcp_f32 v55, v55
buffer_load_dwordx4 v11, s[36:39], s0 offen offset:2048 lds
v_pk_mul_f32 v[160:161], v[160:161], v[40:41]
v_pk_mul_f32 v[162:163], v[162:163], v[42:43]
v_pk_mul_f32 v[164:165], v[164:165], v[44:45]
v_pk_mul_f32 v[166:167], v[166:167], v[46:47]
v_pk_mul_f32 v[168:169], v[168:169], v[48:49]
v_pk_mul_f32 v[170:171], v[170:171], v[50:51]
buffer_load_dwordx4 v255, s[36:39], s0 offen offset:3072 lds
v_pk_mul_f32 v[172:173], v[172:173], v[52:53]
v_pk_mul_f32 v[174:175], v[174:175], v[54:55]
v_cvt_pk_bf16_f32 v88, v160, v161
v_cvt_pk_bf16_f32 v89, v162, v163
v_cvt_pk_bf16_f32 v90, v164, v165
v_cvt_pk_bf16_f32 v91, v166, v167
v_cvt_pk_bf16_f32 v92, v168, v169
v_cvt_pk_bf16_f32 v93, v170, v171
v_cvt_pk_bf16_f32 v94, v172, v173
v_cvt_pk_bf16_f32 v95, v174, v175
ds_write_b64 v116, v[88:89] offset:4096
ds_write_b64 v116, v[90:91] offset:10240
ds_write_b64 v116, v[92:93] offset:16384
ds_write_b64 v116, v[94:95] offset:22528
s_waitcnt lgkmcnt(0)
s_barrier
ds_read_b128 v[40:43], v117 offset:0
ds_read_b128 v[44:47], v117 offset:1024
ds_read_b128 v[48:51], v117 offset:2048
ds_read_b128 v[52:55], v117 offset:3072
ds_read_b128 v[56:59], v117 offset:4096
ds_read_b128 v[60:63], v117 offset:5120
s_waitcnt lgkmcnt(0)
s_cmp_eq_u32 s56, 0
s_cbranch_scc1 Lslow_52
s_nop 0
buffer_store_dwordx4 v[40:43], v118, s[44:47], s8 offen
buffer_store_dwordx4 v[44:47], v118, s[44:47], s9 offen
buffer_store_dwordx4 v[48:51], v118, s[44:47], s10 offen
buffer_store_dwordx4 v[52:55], v118, s[44:47], s11 offen
buffer_store_dwordx4 v[56:59], v118, s[44:47], s12 offen
buffer_store_dwordx4 v[60:63], v118, s[44:47], s13 offen
s_branch Lpub_53
Lslow_52:
s_nop 0
buffer_store_dwordx4 v[40:43], v118, s[44:47], s8 offen sc1
buffer_store_dwordx4 v[44:47], v118, s[44:47], s9 offen sc1
buffer_store_dwordx4 v[48:51], v118, s[44:47], s10 offen sc1
buffer_store_dwordx4 v[52:55], v118, s[44:47], s11 offen sc1
buffer_store_dwordx4 v[56:59], v118, s[44:47], s12 offen sc1
buffer_store_dwordx4 v[60:63], v118, s[44:47], s13 offen sc1
Lpub_53:
s_waitcnt vmcnt(0)
s_mov_b64 exec, 1
s_cmp_eq_u32 s56, 0
s_cbranch_scc1 Lslow_54
buffer_store_dword v9, v113, s[44:47], 0 offen offset:96
s_branch Lpub_55
Lslow_54:
buffer_store_dword v9, v113, s[44:47], 0 offen offset:96 sc1
Lpub_55:
s_mov_b64 exec, -1
s_barrier
s_add_u32 s0, s89, 32
s_sub_u32 s1, s0, 43
s_cmp_lt_u32 s0, 43
s_cselect_b32 s0, s0, s1
s_lshl_b32 s0, s0, 15
s_add_u32 m0, s98, 131072
s_nop 0
s_nop 0
buffer_load_dwordx4 v8, s[36:39], s0 offen offset:0 lds
buffer_load_dwordx4 v10, s[36:39], s0 offen offset:1024 lds
buffer_load_dwordx4 v11, s[36:39], s0 offen offset:2048 lds
buffer_load_dwordx4 v255, s[36:39], s0 offen offset:3072 lds
v_mov_b32_e64 v176, v14
v_add_u32 v180, 0x10000, v14
v_add_u32 v184, 0x20000, v14
v_mov_b32_e64 v177, v15
v_add_u32 v181, 0x10000, v15
v_add_u32 v185, 0x20000, v15
v_mov_b32_e64 v178, v16
v_add_u32 v182, 0x10000, v16
v_add_u32 v186, 0x20000, v16
v_mov_b32_e64 v179, v17
v_add_u32 v183, 0x10000, v17
v_add_u32 v187, 0x20000, v17
v_accvgpr_read_b32 v225, a159
v_accvgpr_read_b32 v224, a160
s_movk_i32 s61, 1
s_cmp_lg_u32 s57, 0
s_cbranch_scc1 Lpoll_56
s_mov_b32 s61, 0x8000
Lpoll_56:
buffer_load_dword v189, v112, s[44:47], 0 offen offset:96 sc1
s_waitcnt vmcnt(0)
v_cmp_ne_u32 vcc, s55, v189
s_cbranch_vccz Lpd_57
s_sub_u32 s61, s61, 1
s_cmp_lg_u32 s61, 0
s_cbranch_scc1 Lpoll_56
s_mov_b32 s57, 1
Lpd_57:
s_barrier
s_mov_b32 s67, 0
buffer_load_dwordx4 v[64:67], v225, s[44:47], s67 offen offset:0 sc1
buffer_load_dwordx4 v[68:71], v225, s[44:47], s67 offen offset:1024 sc1
buffer_load_dwordx4 v[72:75], v225, s[44:47], s67 offen offset:2048 sc1
buffer_load_dwordx4 v[76:79], v225, s[44:47], s67 offen offset:3072 sc1
s_mov_b32 s67, 4096
buffer_load_dwordx4 v[80:83], v225, s[44:47], s67 offen offset:0 sc1
buffer_load_dwordx4 v[84:87], v225, s[44:47], s67 offen offset:1024 sc1
ds_read_b64_tr_b16 v[128:129], v176 offset:16384
ds_read_b64_tr_b16 v[130:131], v176 offset:18432
ds_read_b64_tr_b16 v[132:133], v177 offset:16384
ds_read_b64_tr_b16 v[134:135], v177 offset:18432
ds_read_b64_tr_b16 v[136:137], v178 offset:16384
ds_read_b64_tr_b16 v[138:139], v178 offset:18432
ds_read_b64_tr_b16 v[140:141], v179 offset:16384
ds_read_b64_tr_b16 v[142:143], v179 offset:18432
ds_read_b64_tr_b16 v[144:145], v176 offset:20480
ds_read_b64_tr_b16 v[146:147], v176 offset:22528
ds_read_b64_tr_b16 v[148:149], v177 offset:20480
ds_read_b64_tr_b16 v[150:151], v177 offset:22528
ds_read_b64_tr_b16 v[152:153], v178 offset:20480
ds_read_b64_tr_b16 v[154:155], v178 offset:22528
ds_read_b64_tr_b16 v[156:157], v179 offset:20480
ds_read_b64_tr_b16 v[158:159], v179 offset:22528
ds_read_b64_tr_b16 v[160:161], v176 offset:24576
ds_read_b64_tr_b16 v[162:163], v176 offset:26624
ds_read_b64_tr_b16 v[164:165], v177 offset:24576
ds_read_b64_tr_b16 v[166:167], v177 offset:26624
ds_read_b64_tr_b16 v[168:169], v178 offset:24576
ds_read_b64_tr_b16 v[170:171], v178 offset:26624
ds_read_b64_tr_b16 v[172:173], v179 offset:24576
ds_read_b64_tr_b16 v[174:175], v179 offset:26624
s_waitcnt vmcnt(5) lgkmcnt(15)
v_mfma_f32_16x16x32_bf16 a[240:243], v[128:131], v[64:67], a[240:243]
s_nop 0
buffer_load_dwordx4 v[88:91], v225, s[44:47], s67 offen offset:2048 sc1
ds_read_b64_tr_b16 v[128:129], v176 offset:28672
ds_read_b64_tr_b16 v[130:131], v176 offset:30720
v_mfma_f32_16x16x32_bf16 a[244:247], v[132:135], v[64:67], a[244:247]
ds_read_b64_tr_b16 v[132:133], v177 offset:28672
ds_read_b64_tr_b16 v[134:135], v177 offset:30720
v_mfma_f32_16x16x32_bf16 a[248:251], v[136:139], v[64:67], a[248:251]
ds_read_b64_tr_b16 v[136:137], v178 offset:28672
ds_read_b64_tr_b16 v[138:139], v178 offset:30720
v_mfma_f32_16x16x32_bf16 a[252:255], v[140:143], v[64:67], a[252:255]
ds_read_b64_tr_b16 v[140:141], v179 offset:28672
ds_read_b64_tr_b16 v[142:143], v179 offset:30720
s_waitcnt vmcnt(5)
v_mfma_f32_16x16x32_bf16 a[240:243], v[144:147], v[68:71], a[240:243]
s_nop 0
buffer_load_dwordx4 v[92:95], v225, s[44:47], s67 offen offset:3072 sc1
ds_read_b64_tr_b16 v[144:145], v176 offset:32768
ds_read_b64_tr_b16 v[146:147], v176 offset:34816
v_mfma_f32_16x16x32_bf16 a[244:247], v[148:151], v[68:71], a[244:247]
ds_read_b64_tr_b16 v[148:149], v177 offset:32768
ds_read_b64_tr_b16 v[150:151], v177 offset:34816
v_mfma_f32_16x16x32_bf16 a[248:251], v[152:155], v[68:71], a[248:251]
ds_read_b64_tr_b16 v[152:153], v178 offset:32768
ds_read_b64_tr_b16 v[154:155], v178 offset:34816
v_mfma_f32_16x16x32_bf16 a[252:255], v[156:159], v[68:71], a[252:255]
ds_read_b64_tr_b16 v[156:157], v179 offset:32768
ds_read_b64_tr_b16 v[158:159], v179 offset:34816
s_waitcnt vmcnt(5) lgkmcnt(15)
v_mfma_f32_16x16x32_bf16 a[240:243], v[160:163], v[72:75], a[240:243]
s_nop 0
s_mov_b32 s67, 8192
ds_read_b64_tr_b16 v[160:161], v176 offset:36864
ds_read_b64_tr_b16 v[162:163], v176 offset:38912
v_mfma_f32_16x16x32_bf16 a[244:247], v[164:167], v[72:75], a[244:247]
buffer_load_dwordx4 v[96:99], v225, s[44:47], s67 offen offset:0 sc1
ds_read_b64_tr_b16 v[164:165], v177 offset:36864
ds_read_b64_tr_b16 v[166:167], v177 offset:38912
v_mfma_f32_16x16x32_bf16 a[248:251], v[168:171], v[72:75], a[248:251]
ds_read_b64_tr_b16 v[168:169], v178 offset:36864
ds_read_b64_tr_b16 v[170:171], v178 offset:38912
v_mfma_f32_16x16x32_bf16 a[252:255], v[172:175], v[72:75], a[252:255]
ds_read_b64_tr_b16 v[172:173], v179 offset:36864
ds_read_b64_tr_b16 v[174:175], v179 offset:38912
s_waitcnt vmcnt(5)
v_mfma_f32_16x16x32_bf16 a[240:243], v[128:131], v[76:79], a[240:243]
s_nop 0
buffer_load_dwordx4 v[100:103], v225, s[44:47], s67 offen offset:1024 sc1
ds_read_b64_tr_b16 v[128:129], v176 offset:40960
ds_read_b64_tr_b16 v[130:131], v176 offset:43008
v_mfma_f32_16x16x32_bf16 a[244:247], v[132:135], v[76:79], a[244:247]
ds_read_b64_tr_b16 v[132:133], v177 offset:40960
ds_read_b64_tr_b16 v[134:135], v177 offset:43008
v_mfma_f32_16x16x32_bf16 a[248:251], v[136:139], v[76:79], a[248:251]
ds_read_b64_tr_b16 v[136:137], v178 offset:40960
ds_read_b64_tr_b16 v[138:139], v178 offset:43008
v_mfma_f32_16x16x32_bf16 a[252:255], v[140:143], v[76:79], a[252:255]
ds_read_b64_tr_b16 v[140:141], v179 offset:40960
ds_read_b64_tr_b16 v[142:143], v179 offset:43008
s_waitcnt vmcnt(5) lgkmcnt(15)
v_mfma_f32_16x16x32_bf16 a[240:243], v[144:147], v[80:83], a[240:243]
s_nop 0
buffer_load_dwordx4 v[104:107], v225, s[44:47], s67 offen offset:2048 sc1
ds_read_b64_tr_b16 v[144:145], v176 offset:45056
ds_read_b64_tr_b16 v[146:147], v176 offset:47104
v_mfma_f32_16x16x32_bf16 a[244:247], v[148:151], v[80:83], a[244:247]
ds_read_b64_tr_b16 v[148:149], v177 offset:45056
ds_read_b64_tr_b16 v[150:151], v177 offset:47104
v_mfma_f32_16x16x32_bf16 a[248:251], v[152:155], v[80:83], a[248:251]
ds_read_b64_tr_b16 v[152:153], v178 offset:45056
ds_read_b64_tr_b16 v[154:155], v178 offset:47104
v_mfma_f32_16x16x32_bf16 a[252:255], v[156:159], v[80:83], a[252:255]
ds_read_b64_tr_b16 v[156:157], v179 offset:45056
ds_read_b64_tr_b16 v[158:159], v179 offset:47104
s_waitcnt vmcnt(5)
v_mfma_f32_16x16x32_bf16 a[240:243], v[160:163], v[84:87], a[240:243]
s_nop 0
buffer_load_dwordx4 v[108:111], v225, s[44:47], s67 offen offset:3072 sc1
ds_read_b64_tr_b16 v[160:161], v176 offset:49152
ds_read_b64_tr_b16 v[162:163], v176 offset:51200
v_mfma_f32_16x16x32_bf16 a[244:247], v[164:167], v[84:87], a[244:247]
ds_read_b64_tr_b16 v[164:165], v177 offset:49152
ds_read_b64_tr_b16 v[166:167], v177 offset:51200
v_mfma_f32_16x16x32_bf16 a[248:251], v[168:171], v[84:87], a[248:251]
ds_read_b64_tr_b16 v[168:169], v178 offset:49152
ds_read_b64_tr_b16 v[170:171], v178 offset:51200
v_mfma_f32_16x16x32_bf16 a[252:255], v[172:175], v[84:87], a[252:255]
ds_read_b64_tr_b16 v[172:173], v179 offset:49152
ds_read_b64_tr_b16 v[174:175], v179 offset:51200
s_waitcnt vmcnt(5) lgkmcnt(15)
v_mfma_f32_16x16x32_bf16 a[240:243], v[128:131], v[88:91], a[240:243]
s_nop 0
s_mov_b32 s67, 12288
ds_read_b64_tr_b16 v[128:129], v176 offset:53248
ds_read_b64_tr_b16 v[130:131], v176 offset:55296
v_mfma_f32_16x16x32_bf16 a[244:247], v[132:135], v[88:91], a[244:247]
buffer_load_dwordx4 v[112:115], v225, s[44:47], s67 offen offset:0 sc1
ds_read_b64_tr_b16 v[132:133], v177 offset:53248
ds_read_b64_tr_b16 v[134:135], v177 offset:55296
v_mfma_f32_16x16x32_bf16 a[248:251], v[136:139], v[88:91], a[248:251]
ds_read_b64_tr_b16 v[136:137], v178 offset:53248
ds_read_b64_tr_b16 v[138:139], v178 offset:55296
v_mfma_f32_16x16x32_bf16 a[252:255], v[140:143], v[88:91], a[252:255]
ds_read_b64_tr_b16 v[140:141], v179 offset:53248
ds_read_b64_tr_b16 v[142:143], v179 offset:55296
s_waitcnt vmcnt(5)
v_mfma_f32_16x16x32_bf16 a[240:243], v[144:147], v[92:95], a[240:243]
s_nop 0
buffer_load_dwordx4 v[116:119], v225, s[44:47], s67 offen offset:1024 sc1
ds_read_b64_tr_b16 v[144:145], v176 offset:57344
ds_read_b64_tr_b16 v[146:147], v176 offset:59392
v_mfma_f32_16x16x32_bf16 a[244:247], v[148:151], v[92:95], a[244:247]
ds_read_b64_tr_b16 v[148:149], v177 offset:57344
ds_read_b64_tr_b16 v[150:151], v177 offset:59392
v_mfma_f32_16x16x32_bf16 a[248:251], v[152:155], v[92:95], a[248:251]
ds_read_b64_tr_b16 v[152:153], v178 offset:57344
ds_read_b64_tr_b16 v[154:155], v178 offset:59392
v_mfma_f32_16x16x32_bf16 a[252:255], v[156:159], v[92:95], a[252:255]
ds_read_b64_tr_b16 v[156:157], v179 offset:57344
ds_read_b64_tr_b16 v[158:159], v179 offset:59392
s_barrier
s_waitcnt vmcnt(5) lgkmcnt(15)
v_mfma_f32_16x16x32_bf16 a[240:243], v[160:163], v[96:99], a[240:243]
buffer_load_dwordx4 v[120:123], v225, s[44:47], s67 offen offset:2048 sc1
ds_read_b64_tr_b16 v[160:161], v176 offset:61440
ds_read_b64_tr_b16 v[162:163], v176 offset:63488
v_mfma_f32_16x16x32_bf16 a[244:247], v[164:167], v[96:99], a[244:247]
s_add_u32 s0, s89, 36
ds_read_b64_tr_b16 v[164:165], v177 offset:61440
ds_read_b64_tr_b16 v[166:167], v177 offset:63488
v_mfma_f32_16x16x32_bf16 a[248:251], v[168:171], v[96:99], a[248:251]
s_sub_u32 s1, s0, 43
ds_read_b64_tr_b16 v[168:169], v178 offset:61440
ds_read_b64_tr_b16 v[170:171], v178 offset:63488
v_mfma_f32_16x16x32_bf16 a[252:255], v[172:175], v[96:99], a[252:255]
s_cmp_lt_u32 s0, 43
ds_read_b64_tr_b16 v[172:173], v179 offset:61440
ds_read_b64_tr_b16 v[174:175], v179 offset:63488
s_cselect_b32 s0, s0, s1
s_lshl_b32 s0, s0, 15
s_add_u32 m0, s98, 16384
s_nop 0
buffer_load_dwordx4 v8, s[36:39], s0 offen offset:0 lds
buffer_load_dwordx4 v10, s[36:39], s0 offen offset:1024 lds
buffer_load_dwordx4 v11, s[36:39], s0 offen offset:2048 lds
buffer_load_dwordx4 v255, s[36:39], s0 offen offset:3072 lds
s_waitcnt vmcnt(9)
v_mfma_f32_16x16x32_bf16 a[240:243], v[128:131], v[100:103], a[240:243]
s_nop 0
buffer_load_dwordx4 v[124:127], v225, s[44:47], s67 offen offset:3072 sc1
ds_read_b64_tr_b16 v[128:129], v180 offset:0
ds_read_b64_tr_b16 v[130:131], v180 offset:2048
v_mfma_f32_16x16x32_bf16 a[244:247], v[132:135], v[100:103], a[244:247]
ds_read_b64_tr_b16 v[132:133], v181 offset:0
ds_read_b64_tr_b16 v[134:135], v181 offset:2048
v_mfma_f32_16x16x32_bf16 a[248:251], v[136:139], v[100:103], a[248:251]
ds_read_b64_tr_b16 v[136:137], v182 offset:0
ds_read_b64_tr_b16 v[138:139], v182 offset:2048
v_mfma_f32_16x16x32_bf16 a[252:255], v[140:143], v[100:103], a[252:255]
ds_read_b64_tr_b16 v[140:141], v183 offset:0
ds_read_b64_tr_b16 v[142:143], v183 offset:2048
s_waitcnt vmcnt(9) lgkmcnt(15)
v_mfma_f32_16x16x32_bf16 a[240:243], v[144:147], v[104:107], a[240:243]
s_nop 0
s_mov_b32 s67, 16384
ds_read_b64_tr_b16 v[144:145], v180 offset:4096
ds_read_b64_tr_b16 v[146:147], v180 offset:6144
v_mfma_f32_16x16x32_bf16 a[244:247], v[148:151], v[104:107], a[244:247]
buffer_load_dwordx4 v[64:67], v225, s[44:47], s67 offen offset:0 sc1
ds_read_b64_tr_b16 v[148:149], v181 offset:4096
ds_read_b64_tr_b16 v[150:151], v181 offset:6144
v_mfma_f32_16x16x32_bf16 a[248:251], v[152:155], v[104:107], a[248:251]
ds_read_b64_tr_b16 v[152:153], v182 offset:4096
ds_read_b64_tr_b16 v[154:155], v182 offset:6144
v_mfma_f32_16x16x32_bf16 a[252:255], v[156:159], v[104:107], a[252:255]
ds_read_b64_tr_b16 v[156:157], v183 offset:4096
ds_read_b64_tr_b16 v[158:159], v183 offset:6144
s_waitcnt vmcnt(9)
v_mfma_f32_16x16x32_bf16 a[240:243], v[160:163], v[108:111], a[240:243]
s_nop 0
buffer_load_dwordx4 v[68:71], v225, s[44:47], s67 offen offset:1024 sc1
ds_read_b64_tr_b16 v[160:161], v180 offset:8192
ds_read_b64_tr_b16 v[162:163], v180 offset:10240
v_mfma_f32_16x16x32_bf16 a[244:247], v[164:167], v[108:111], a[244:247]
s_branch Lpg_8_n
.p2align 12
Lpg_8:
s_setpc_b64 s[100:101]
s_nop 0
Lpg_8_n:
s_add_u32 s0, s89, 40
ds_read_b64_tr_b16 v[164:165], v181 offset:8192
ds_read_b64_tr_b16 v[166:167], v181 offset:10240
v_mfma_f32_16x16x32_bf16 a[248:251], v[168:171], v[108:111], a[248:251]
s_sub_u32 s1, s0, 43
ds_read_b64_tr_b16 v[168:169], v182 offset:8192
ds_read_b64_tr_b16 v[170:171], v182 offset:10240
v_mfma_f32_16x16x32_bf16 a[252:255], v[172:175], v[108:111], a[252:255]
s_cmp_lt_u32 s0, 43
ds_read_b64_tr_b16 v[172:173], v183 offset:8192
ds_read_b64_tr_b16 v[174:175], v183 offset:10240
s_cselect_b32 s0, s0, s1
s_lshl_b32 s0, s0, 15
s_cmp_eq_u32 s52, 3
s_cselect_b32 s0, 0x40000000, s0
s_add_u32 m0, s98, 32768
s_nop 0
buffer_load_dwordx4 v8, s[36:39], s0 offen offset:0 lds
buffer_load_dwordx4 v10, s[36:39], s0 offen offset:1024 lds
buffer_load_dwordx4 v11, s[36:39], s0 offen offset:2048 lds
buffer_load_dwordx4 v255, s[36:39], s0 offen offset:3072 lds
s_waitcnt vmcnt(13) lgkmcnt(15)
v_mfma_f32_16x16x32_bf16 a[240:243], v[128:131], v[112:115], a[240:243]
s_nop 0
buffer_load_dwordx4 v[72:75], v225, s[44:47], s67 offen offset:2048 sc1
ds_read_b64_tr_b16 v[128:129], v180 offset:12288
ds_read_b64_tr_b16 v[130:131], v180 offset:14336
v_mfma_f32_16x16x32_bf16 a[244:247], v[132:135], v[112:115], a[244:247]
ds_read_b64_tr_b16 v[132:133], v181 offset:12288
ds_read_b64_tr_b16 v[134:135], v181 offset:14336
v_mfma_f32_16x16x32_bf16 a[248:251], v[136:139], v[112:115], a[248:251]
ds_read_b64_tr_b16 v[136:137], v182 offset:12288
ds_read_b64_tr_b16 v[138:139], v182 offset:14336
v_mfma_f32_16x16x32_bf16 a[252:255], v[140:143], v[112:115], a[252:255]
ds_read_b64_tr_b16 v[140:141], v183 offset:12288
ds_read_b64_tr_b16 v[142:143], v183 offset:14336
s_waitcnt vmcnt(13)
v_mfma_f32_16x16x32_bf16 a[240:243], v[144:147], v[116:119], a[240:243]
s_nop 0
buffer_load_dwordx4 v[76:79], v225, s[44:47], s67 offen offset:3072 sc1
ds_read_b64_tr_b16 v[144:145], v180 offset:16384
ds_read_b64_tr_b16 v[146:147], v180 offset:18432
v_mfma_f32_16x16x32_bf16 a[244:247], v[148:151], v[116:119], a[244:247]
ds_read_b64_tr_b16 v[148:149], v181 offset:16384
ds_read_b64_tr_b16 v[150:151], v181 offset:18432
v_mfma_f32_16x16x32_bf16 a[248:251], v[152:155], v[116:119], a[248:251]
ds_read_b64_tr_b16 v[152:153], v182 offset:16384
ds_read_b64_tr_b16 v[154:155], v182 offset:18432
v_mfma_f32_16x16x32_bf16 a[252:255], v[156:159], v[116:119], a[252:255]
ds_read_b64_tr_b16 v[156:157], v183 offset:16384
ds_read_b64_tr_b16 v[158:159], v183 offset:18432
s_waitcnt vmcnt(13) lgkmcnt(15)
v_mfma_f32_16x16x32_bf16 a[240:243], v[160:163], v[120:123], a[240:243]
s_nop 0
s_mov_b32 s67, 20480
ds_read_b64_tr_b16 v[160:161], v180 offset:20480
ds_read_b64_tr_b16 v[162:163], v180 offset:22528
v_mfma_f32_16x16x32_bf16 a[244:247], v[164:167], v[120:123], a[244:247]
buffer_load_dwordx4 v[80:83], v225, s[44:47], s67 offen offset:0 sc1
ds_read_b64_tr_b16 v[164:165], v181 offset:20480
ds_read_b64_tr_b16 v[166:167], v181 offset:22528
v_mfma_f32_16x16x32_bf16 a[248:251], v[168:171], v[120:123], a[248:251]
ds_read_b64_tr_b16 v[168:169], v182 offset:20480
ds_read_b64_tr_b16 v[170:171], v182 offset:22528
v_mfma_f32_16x16x32_bf16 a[252:255], v[172:175], v[120:123], a[252:255]
ds_read_b64_tr_b16 v[172:173], v183 offset:20480
ds_read_b64_tr_b16 v[174:175], v183 offset:22528
s_waitcnt vmcnt(9)
v_mfma_f32_16x16x32_bf16 a[240:243], v[128:131], v[124:127], a[240:243]
s_nop 0
buffer_load_dwordx4 v[84:87], v225, s[44:47], s67 offen offset:1024 sc1
ds_read_b64_tr_b16 v[128:129], v180 offset:24576
ds_read_b64_tr_b16 v[130:131], v180 offset:26624
v_mfma_f32_16x16x32_bf16 a[244:247], v[132:135], v[124:127], a[244:247]
ds_read_b64_tr_b16 v[132:133], v181 offset:24576
ds_read_b64_tr_b16 v[134:135], v181 offset:26624
v_mfma_f32_16x16x32_bf16 a[248:251], v[136:139], v[124:127], a[248:251]
ds_read_b64_tr_b16 v[136:137], v182 offset:24576
ds_read_b64_tr_b16 v[138:139], v182 offset:26624
v_mfma_f32_16x16x32_bf16 a[252:255], v[140:143], v[124:127], a[252:255]
ds_read_b64_tr_b16 v[140:141], v183 offset:24576
ds_read_b64_tr_b16 v[142:143], v183 offset:26624
s_waitcnt vmcnt(9) lgkmcnt(15)
v_mfma_f32_16x16x32_bf16 a[240:243], v[144:147], v[64:67], a[240:243]
s_nop 0
buffer_load_dwordx4 v[88:91], v225, s[44:47], s67 offen offset:2048 sc1
ds_read_b64_tr_b16 v[144:145], v180 offset:28672
ds_read_b64_tr_b16 v[146:147], v180 offset:30720
v_mfma_f32_16x16x32_bf16 a[244:247], v[148:151], v[64:67], a[244:247]
ds_read_b64_tr_b16 v[148:149], v181 offset:28672
ds_read_b64_tr_b16 v[150:151], v181 offset:30720
v_mfma_f32_16x16x32_bf16 a[248:251], v[152:155], v[64:67], a[248:251]
ds_read_b64_tr_b16 v[152:153], v182 offset:28672
ds_read_b64_tr_b16 v[154:155], v182 offset:30720
v_mfma_f32_16x16x32_bf16 a[252:255], v[156:159], v[64:67], a[252:255]
ds_read_b64_tr_b16 v[156:157], v183 offset:28672
ds_read_b64_tr_b16 v[158:159], v183 offset:30720
s_waitcnt vmcnt(9)
v_mfma_f32_16x16x32_bf16 a[240:243], v[160:163], v[68:71], a[240:243]
s_nop 0
buffer_load_dwordx4 v[92:95], v225, s[44:47], s67 offen offset:3072 sc1
ds_read_b64_tr_b16 v[160:161], v180 offset:32768
ds_read_b64_tr_b16 v[162:163], v180 offset:34816
v_mfma_f32_16x16x32_bf16 a[244:247], v[164:167], v[68:71], a[244:247]
ds_read_b64_tr_b16 v[164:165], v181 offset:32768
ds_read_b64_tr_b16 v[166:167], v181 offset:34816
v_mfma_f32_16x16x32_bf16 a[248:251], v[168:171], v[68:71], a[248:251]
ds_read_b64_tr_b16 v[168:169], v182 offset:32768
ds_read_b64_tr_b16 v[170:171], v182 offset:34816
v_mfma_f32_16x16x32_bf16 a[252:255], v[172:175], v[68:71], a[252:255]
ds_read_b64_tr_b16 v[172:173], v183 offset:32768
ds_read_b64_tr_b16 v[174:175], v183 offset:34816
s_waitcnt vmcnt(5) lgkmcnt(15)
v_mfma_f32_16x16x32_bf16 a[240:243], v[128:131], v[72:75], a[240:243]
s_nop 0
s_mov_b32 s67, 24576
ds_read_b64_tr_b16 v[128:129], v180 offset:36864
ds_read_b64_tr_b16 v[130:131], v180 offset:38912
v_mfma_f32_16x16x32_bf16 a[244:247], v[132:135], v[72:75], a[244:247]
buffer_load_dwordx4 v[96:99], v225, s[44:47], s67 offen offset:0 sc1
ds_read_b64_tr_b16 v[132:133], v181 offset:36864
ds_read_b64_tr_b16 v[134:135], v181 offset:38912
v_mfma_f32_16x16x32_bf16 a[248:251], v[136:139], v[72:75], a[248:251]
ds_read_b64_tr_b16 v[136:137], v182 offset:36864
ds_read_b64_tr_b16 v[138:139], v182 offset:38912
v_mfma_f32_16x16x32_bf16 a[252:255], v[140:143], v[72:75], a[252:255]
ds_read_b64_tr_b16 v[140:141], v183 offset:36864
ds_read_b64_tr_b16 v[142:143], v183 offset:38912
s_waitcnt vmcnt(5)
v_mfma_f32_16x16x32_bf16 a[240:243], v[144:147], v[76:79], a[240:243]
s_nop 0
buffer_load_dwordx4 v[100:103], v225, s[44:47], s67 offen offset:1024 sc1
ds_read_b64_tr_b16 v[144:145], v180 offset:40960
ds_read_b64_tr_b16 v[146:147], v180 offset:43008
v_mfma_f32_16x16x32_bf16 a[244:247], v[148:151], v[76:79], a[244:247]
ds_read_b64_tr_b16 v[148:149], v181 offset:40960
ds_read_b64_tr_b16 v[150:151], v181 offset:43008
v_mfma_f32_16x16x32_bf16 a[248:251], v[152:155], v[76:79], a[248:251]
ds_read_b64_tr_b16 v[152:153], v182 offset:40960
ds_read_b64_tr_b16 v[154:155], v182 offset:43008
v_mfma_f32_16x16x32_bf16 a[252:255], v[156:159], v[76:79], a[252:255]
ds_read_b64_tr_b16 v[156:157], v183 offset:40960
ds_read_b64_tr_b16 v[158:159], v183 offset:43008
s_waitcnt vmcnt(5) lgkmcnt(15)
v_mfma_f32_16x16x32_bf16 a[240:243], v[160:163], v[80:83], a[240:243]
s_nop 0
buffer_load_dwordx4 v[104:107], v225, s[44:47], s67 offen offset:2048 sc1
ds_read_b64_tr_b16 v[160:161], v180 offset:45056
ds_read_b64_tr_b16 v[162:163], v180 offset:47104
v_mfma_f32_16x16x32_bf16 a[244:247], v[164:167], v[80:83], a[244:247]
ds_read_b64_tr_b16 v[164:165], v181 offset:45056
ds_read_b64_tr_b16 v[166:167], v181 offset:47104
v_mfma_f32_16x16x32_bf16 a[248:251], v[168:171], v[80:83], a[248:251]
ds_read_b64_tr_b16 v[168:169], v182 offset:45056
ds_read_b64_tr_b16 v[170:171], v182 offset:47104
v_mfma_f32_16x16x32_bf16 a[252:255], v[172:175], v[80:83], a[252:255]
ds_read_b64_tr_b16 v[172:173], v183 offset:45056
ds_read_b64_tr_b16 v[174:175], v183 offset:47104
s_waitcnt vmcnt(5)
v_mfma_f32_16x16x32_bf16 a[240:243], v[128:131], v[84:87], a[240:243]
s_nop 0
buffer_load_dwordx4 v[108:111], v225, s[44:47], s67 offen offset:3072 sc1
ds_read_b64_tr_b16 v[128:129], v180 offset:49152
ds_read_b64_tr_b16 v[130:131], v180 offset:51200
v_mfma_f32_16x16x32_bf16 a[244:247], v[132:135], v[84:87], a[244:247]
ds_read_b64_tr_b16 v[132:133], v181 offset:49152
ds_read_b64_tr_b16 v[134:135], v181 offset:51200
v_mfma_f32_16x16x32_bf16 a[248:251], v[136:139], v[84:87], a[248:251]
ds_read_b64_tr_b16 v[136:137], v182 offset:49152
ds_read_b64_tr_b16 v[138:139], v182 offset:51200
v_mfma_f32_16x16x32_bf16 a[252:255], v[140:143], v[84:87], a[252:255]
ds_read_b64_tr_b16 v[140:141], v183 offset:49152
ds_read_b64_tr_b16 v[142:143], v183 offset:51200
s_waitcnt vmcnt(5) lgkmcnt(15)
v_mfma_f32_16x16x32_bf16 a[240:243], v[144:147], v[88:91], a[240:243]
s_nop 0
s_mov_b32 s67, 28672
ds_read_b64_tr_b16 v[144:145], v180 offset:53248
ds_read_b64_tr_b16 v[146:147], v180 offset:55296
v_mfma_f32_16x16x32_bf16 a[244:247], v[148:151], v[88:91], a[244:247]
buffer_load_dwordx4 v[112:115], v225, s[44:47], s67 offen offset:0 sc1
ds_read_b64_tr_b16 v[148:149], v181 offset:53248
ds_read_b64_tr_b16 v[150:151], v181 offset:55296
v_mfma_f32_16x16x32_bf16 a[248:251], v[152:155], v[88:91], a[248:251]
ds_read_b64_tr_b16 v[152:153], v182 offset:53248
ds_read_b64_tr_b16 v[154:155], v182 offset:55296
v_mfma_f32_16x16x32_bf16 a[252:255], v[156:159], v[88:91], a[252:255]
ds_read_b64_tr_b16 v[156:157], v183 offset:53248
ds_read_b64_tr_b16 v[158:159], v183 offset:55296
s_waitcnt vmcnt(5)
v_mfma_f32_16x16x32_bf16 a[240:243], v[160:163], v[92:95], a[240:243]
s_nop 0
buffer_load_dwordx4 v[116:119], v225, s[44:47], s67 offen offset:1024 sc1
ds_read_b64_tr_b16 v[160:161], v180 offset:57344
ds_read_b64_tr_b16 v[162:163], v180 offset:59392
v_mfma_f32_16x16x32_bf16 a[244:247], v[164:167], v[92:95], a[244:247]
ds_read_b64_tr_b16 v[164:165], v181 offset:57344
ds_read_b64_tr_b16 v[166:167], v181 offset:59392
v_mfma_f32_16x16x32_bf16 a[248:251], v[168:171], v[92:95], a[248:251]
ds_read_b64_tr_b16 v[168:169], v182 offset:57344
ds_read_b64_tr_b16 v[170:171], v182 offset:59392
v_mfma_f32_16x16x32_bf16 a[252:255], v[172:175], v[92:95], a[252:255]
ds_read_b64_tr_b16 v[172:173], v183 offset:57344
ds_read_b64_tr_b16 v[174:175], v183 offset:59392
s_waitcnt vmcnt(5) lgkmcnt(15)
v_mfma_f32_16x16x32_bf16 a[240:243], v[128:131], v[96:99], a[240:243]
s_nop 0
buffer_load_dwordx4 v[120:123], v225, s[44:47], s67 offen offset:2048 sc1
ds_read_b64_tr_b16 v[128:129], v180 offset:61440
ds_read_b64_tr_b16 v[130:131], v180 offset:63488
v_mfma_f32_16x16x32_bf16 a[244:247], v[132:135], v[96:99], a[244:247]
ds_read_b64_tr_b16 v[132:133], v181 offset:61440
ds_read_b64_tr_b16 v[134:135], v181 offset:63488
v_mfma_f32_16x16x32_bf16 a[248:251], v[136:139], v[96:99], a[248:251]
ds_read_b64_tr_b16 v[136:137], v182 offset:61440
ds_read_b64_tr_b16 v[138:139], v182 offset:63488
v_mfma_f32_16x16x32_bf16 a[252:255], v[140:143], v[96:99], a[252:255]
ds_read_b64_tr_b16 v[140:141], v183 offset:61440
ds_read_b64_tr_b16 v[142:143], v183 offset:63488
s_waitcnt vmcnt(5)
v_mfma_f32_16x16x32_bf16 a[240:243], v[144:147], v[100:103], a[240:243]
s_nop 0
buffer_load_dwordx4 v[124:127], v225, s[44:47], s67 offen offset:3072 sc1
ds_read_b64_tr_b16 v[144:145], v176 offset:0
ds_read_b64_tr_b16 v[146:147], v176 offset:2048
v_mfma_f32_16x16x32_bf16 a[244:247], v[148:151], v[100:103], a[244:247]
ds_read_b64_tr_b16 v[148:149], v177 offset:0
ds_read_b64_tr_b16 v[150:151], v177 offset:2048
v_mfma_f32_16x16x32_bf16 a[248:251], v[152:155], v[100:103], a[248:251]
ds_read_b64_tr_b16 v[152:153], v178 offset:0
ds_read_b64_tr_b16 v[154:155], v178 offset:2048
v_mfma_f32_16x16x32_bf16 a[252:255], v[156:159], v[100:103], a[252:255]
ds_read_b64_tr_b16 v[156:157], v179 offset:0
ds_read_b64_tr_b16 v[158:159], v179 offset:2048
s_waitcnt vmcnt(5) lgkmcnt(15)
v_mfma_f32_16x16x32_bf16 a[240:243], v[160:163], v[104:107], a[240:243]
s_nop 0
s_mov_b32 s67, 32768
ds_read_b64_tr_b16 v[160:161], v176 offset:4096
ds_read_b64_tr_b16 v[162:163], v176 offset:6144
v_mfma_f32_16x16x32_bf16 a[244:247], v[164:167], v[104:107], a[244:247]
buffer_load_dwordx4 v[64:67], v225, s[44:47], s67 offen offset:0 sc1
ds_read_b64_tr_b16 v[164:165], v177 offset:4096
ds_read_b64_tr_b16 v[166:167], v177 offset:6144
v_mfma_f32_16x16x32_bf16 a[248:251], v[168:171], v[104:107], a[248:251]
ds_read_b64_tr_b16 v[168:169], v178 offset:4096
ds_read_b64_tr_b16 v[170:171], v178 offset:6144
v_mfma_f32_16x16x32_bf16 a[252:255], v[172:175], v[104:107], a[252:255]
ds_read_b64_tr_b16 v[172:173], v179 offset:4096
ds_read_b64_tr_b16 v[174:175], v179 offset:6144
s_waitcnt vmcnt(5)
v_mfma_f32_16x16x32_bf16 a[240:243], v[128:131], v[108:111], a[240:243]
s_nop 0
buffer_load_dwordx4 v[68:71], v225, s[44:47], s67 offen offset:1024 sc1
ds_read_b64_tr_b16 v[128:129], v176 offset:8192
ds_read_b64_tr_b16 v[130:131], v176 offset:10240
v_mfma_f32_16x16x32_bf16 a[244:247], v[132:135], v[108:111], a[244:247]
ds_read_b64_tr_b16 v[132:133], v177 offset:8192
ds_read_b64_tr_b16 v[134:135], v177 offset:10240
v_mfma_f32_16x16x32_bf16 a[248:251], v[136:139], v[108:111], a[248:251]
ds_read_b64_tr_b16 v[136:137], v178 offset:8192
ds_read_b64_tr_b16 v[138:139], v178 offset:10240
v_mfma_f32_16x16x32_bf16 a[252:255], v[140:143], v[108:111], a[252:255]
ds_read_b64_tr_b16 v[140:141], v179 offset:8192
ds_read_b64_tr_b16 v[142:143], v179 offset:10240
s_waitcnt vmcnt(5) lgkmcnt(15)
v_mfma_f32_16x16x32_bf16 a[240:243], v[144:147], v[112:115], a[240:243]
s_nop 0
buffer_load_dwordx4 v[72:75], v225, s[44:47], s67 offen offset:2048 sc1
ds_read_b64_tr_b16 v[144:145], v176 offset:12288
ds_read_b64_tr_b16 v[146:147], v176 offset:14336
v_mfma_f32_16x16x32_bf16 a[244:247], v[148:151], v[112:115], a[244:247]
ds_read_b64_tr_b16 v[148:149], v177 offset:12288
ds_read_b64_tr_b16 v[150:151], v177 offset:14336
v_mfma_f32_16x16x32_bf16 a[248:251], v[152:155], v[112:115], a[248:251]
ds_read_b64_tr_b16 v[152:153], v178 offset:12288
ds_read_b64_tr_b16 v[154:155], v178 offset:14336
v_mfma_f32_16x16x32_bf16 a[252:255], v[156:159], v[112:115], a[252:255]
ds_read_b64_tr_b16 v[156:157], v179 offset:12288
ds_read_b64_tr_b16 v[158:159], v179 offset:14336
s_waitcnt vmcnt(5)
v_mfma_f32_16x16x32_bf16 a[240:243], v[160:163], v[116:119], a[240:243]
s_nop 0
buffer_load_dwordx4 v[76:79], v225, s[44:47], s67 offen offset:3072 sc1
ds_read_b64_tr_b16 v[160:161], v184 offset:0
ds_read_b64_tr_b16 v[162:163], v184 offset:2048
v_mfma_f32_16x16x32_bf16 a[244:247], v[164:167], v[116:119], a[244:247]
ds_read_b64_tr_b16 v[164:165], v185 offset:0
ds_read_b64_tr_b16 v[166:167], v185 offset:2048
v_mfma_f32_16x16x32_bf16 a[248:251], v[168:171], v[116:119], a[248:251]
ds_read_b64_tr_b16 v[168:169], v186 offset:0
ds_read_b64_tr_b16 v[170:171], v186 offset:2048
v_mfma_f32_16x16x32_bf16 a[252:255], v[172:175], v[116:119], a[252:255]
ds_read_b64_tr_b16 v[172:173], v187 offset:0
ds_read_b64_tr_b16 v[174:175], v187 offset:2048
s_waitcnt vmcnt(5) lgkmcnt(15)
v_mfma_f32_16x16x32_bf16 a[240:243], v[128:131], v[120:123], a[240:243]
s_nop 0
s_mov_b32 s67, 36864
ds_read_b64_tr_b16 v[128:129], v184 offset:4096
ds_read_b64_tr_b16 v[130:131], v184 offset:6144
v_mfma_f32_16x16x32_bf16 a[244:247], v[132:135], v[120:123], a[244:247]
buffer_load_dwordx4 v[80:83], v225, s[44:47], s67 offen offset:0 sc1
ds_read_b64_tr_b16 v[132:133], v185 offset:4096
ds_read_b64_tr_b16 v[134:135], v185 offset:6144
v_mfma_f32_16x16x32_bf16 a[248:251], v[136:139], v[120:123], a[248:251]
ds_read_b64_tr_b16 v[136:137], v186 offset:4096
ds_read_b64_tr_b16 v[138:139], v186 offset:6144
v_mfma_f32_16x16x32_bf16 a[252:255], v[140:143], v[120:123], a[252:255]
ds_read_b64_tr_b16 v[140:141], v187 offset:4096
ds_read_b64_tr_b16 v[142:143], v187 offset:6144
s_barrier
s_waitcnt vmcnt(5)
v_mfma_f32_16x16x32_bf16 a[240:243], v[144:147], v[124:127], a[240:243]
buffer_load_dwordx4 v[84:87], v225, s[44:47], s67 offen offset:1024 sc1
ds_read_b64_tr_b16 v[144:145], v184 offset:8192
ds_read_b64_tr_b16 v[146:147], v184 offset:10240
v_mfma_f32_16x16x32_bf16 a[244:247], v[148:151], v[124:127], a[244:247]
ds_read_b64_tr_b16 v[148:149], v185 offset:8192
ds_read_b64_tr_b16 v[150:151], v185 offset:10240
v_mfma_f32_16x16x32_bf16 a[248:251], v[152:155], v[124:127], a[248:251]
ds_read_b64_tr_b16 v[152:153], v186 offset:8192
ds_read_b64_tr_b16 v[154:155], v186 offset:10240
v_mfma_f32_16x16x32_bf16 a[252:255], v[156:159], v[124:127], a[252:255]
ds_read_b64_tr_b16 v[156:157], v187 offset:8192
ds_read_b64_tr_b16 v[158:159], v187 offset:10240
s_waitcnt vmcnt(5) lgkmcnt(15)
v_mfma_f32_16x16x32_bf16 a[240:243], v[160:163], v[64:67], a[240:243]
s_nop 0
buffer_load_dwordx4 v[88:91], v225, s[44:47], s67 offen offset:2048 sc1
ds_read_b64_tr_b16 v[160:161], v184 offset:12288
ds_read_b64_tr_b16 v[162:163], v184 offset:14336
v_mfma_f32_16x16x32_bf16 a[244:247], v[164:167], v[64:67], a[244:247]
ds_read_b64_tr_b16 v[164:165], v185 offset:12288
ds_read_b64_tr_b16 v[166:167], v185 offset:14336
v_mfma_f32_16x16x32_bf16 a[248:251], v[168:171], v[64:67], a[248:251]
ds_read_b64_tr_b16 v[168:169], v186 offset:12288
ds_read_b64_tr_b16 v[170:171], v186 offset:14336
v_mfma_f32_16x16x32_bf16 a[252:255], v[172:175], v[64:67], a[252:255]
ds_read_b64_tr_b16 v[172:173], v187 offset:12288
ds_read_b64_tr_b16 v[174:175], v187 offset:14336
s_waitcnt vmcnt(5)
v_mfma_f32_16x16x32_bf16 a[240:243], v[128:131], v[68:71], a[240:243]
s_nop 0
buffer_load_dwordx4 v[92:95], v225, s[44:47], s67 offen offset:3072 sc1
ds_read_b64_tr_b16 v[128:129], v176 offset:16384
ds_read_b64_tr_b16 v[130:131], v176 offset:18432
v_mfma_f32_16x16x32_bf16 a[244:247], v[132:135], v[68:71], a[244:247]
ds_read_b64_tr_b16 v[132:133], v177 offset:16384
ds_read_b64_tr_b16 v[134:135], v177 offset:18432
v_mfma_f32_16x16x32_bf16 a[248:251], v[136:139], v[68:71], a[248:251]
ds_read_b64_tr_b16 v[136:137], v178 offset:16384
ds_read_b64_tr_b16 v[138:139], v178 offset:18432
v_mfma_f32_16x16x32_bf16 a[252:255], v[140:143], v[68:71], a[252:255]
ds_read_b64_tr_b16 v[140:141], v179 offset:16384
ds_read_b64_tr_b16 v[142:143], v179 offset:18432
s_waitcnt vmcnt(5) lgkmcnt(15)
v_mfma_f32_16x16x32_bf16 a[240:243], v[144:147], v[72:75], a[240:243]
s_nop 0
s_mov_b32 s67, 40960
ds_read_b64_tr_b16 v[144:145], v176 offset:20480
ds_read_b64_tr_b16 v[146:147], v176 offset:22528
v_mfma_f32_16x16x32_bf16 a[244:247], v[148:151], v[72:75], a[244:247]
buffer_load_dwordx4 v[96:99], v225, s[44:47], s67 offen offset:0 sc1
ds_read_b64_tr_b16 v[148:149], v177 offset:20480
ds_read_b64_tr_b16 v[150:151], v177 offset:22528
v_mfma_f32_16x16x32_bf16 a[248:251], v[152:155], v[72:75], a[248:251]
ds_read_b64_tr_b16 v[152:153], v178 offset:20480
ds_read_b64_tr_b16 v[154:155], v178 offset:22528
v_mfma_f32_16x16x32_bf16 a[252:255], v[156:159], v[72:75], a[252:255]
ds_read_b64_tr_b16 v[156:157], v179 offset:20480
ds_read_b64_tr_b16 v[158:159], v179 offset:22528
s_waitcnt vmcnt(5)
v_mfma_f32_16x16x32_bf16 a[240:243], v[160:163], v[76:79], a[240:243]
s_nop 0
buffer_load_dwordx4 v[100:103], v225, s[44:47], s67 offen offset:1024 sc1
ds_read_b64_tr_b16 v[160:161], v176 offset:24576
ds_read_b64_tr_b16 v[162:163], v176 offset:26624
v_mfma_f32_16x16x32_bf16 a[244:247], v[164:167], v[76:79], a[244:247]
ds_read_b64_tr_b16 v[164:165], v177 offset:24576
ds_read_b64_tr_b16 v[166:167], v177 offset:26624
v_mfma_f32_16x16x32_bf16 a[248:251], v[168:171], v[76:79], a[248:251]
ds_read_b64_tr_b16 v[168:169], v178 offset:24576
ds_read_b64_tr_b16 v[170:171], v178 offset:26624
v_mfma_f32_16x16x32_bf16 a[252:255], v[172:175], v[76:79], a[252:255]
ds_read_b64_tr_b16 v[172:173], v179 offset:24576
ds_read_b64_tr_b16 v[174:175], v179 offset:26624
s_waitcnt vmcnt(5) lgkmcnt(15)
v_mfma_f32_16x16x32_bf16 a[240:243], v[128:131], v[80:83], a[240:243]
s_nop 0
buffer_load_dwordx4 v[104:107], v225, s[44:47], s67 offen offset:2048 sc1
ds_read_b64_tr_b16 v[128:129], v176 offset:28672
ds_read_b64_tr_b16 v[130:131], v176 offset:30720
v_mfma_f32_16x16x32_bf16 a[244:247], v[132:135], v[80:83], a[244:247]
ds_read_b64_tr_b16 v[132:133], v177 offset:28672
ds_read_b64_tr_b16 v[134:135], v177 offset:30720
v_mfma_f32_16x16x32_bf16 a[248:251], v[136:139], v[80:83], a[248:251]
ds_read_b64_tr_b16 v[136:137], v178 offset:28672
ds_read_b64_tr_b16 v[138:139], v178 offset:30720
v_mfma_f32_16x16x32_bf16 a[252:255], v[140:143], v[80:83], a[252:255]
ds_read_b64_tr_b16 v[140:141], v179 offset:28672
ds_read_b64_tr_b16 v[142:143], v179 offset:30720
s_waitcnt vmcnt(5)
v_mfma_f32_16x16x32_bf16 a[240:243], v[144:147], v[84:87], a[240:243]
ds_read_b64_tr_b16 v[144:145], v176 offset:32768
ds_read_b64_tr_b16 v[146:147], v176 offset:34816
v_mfma_f32_16x16x32_bf16 a[244:247], v[148:151], v[84:87], a[244:247]
ds_read_b64_tr_b16 v[148:149], v177 offset:32768
ds_read_b64_tr_b16 v[150:151], v177 offset:34816
v_mfma_f32_16x16x32_bf16 a[248:251], v[152:155], v[84:87], a[248:251]
ds_read_b64_tr_b16 v[152:153], v178 offset:32768
ds_read_b64_tr_b16 v[154:155], v178 offset:34816
v_mfma_f32_16x16x32_bf16 a[252:255], v[156:159], v[84:87], a[252:255]
ds_read_b64_tr_b16 v[156:157], v179 offset:32768
ds_read_b64_tr_b16 v[158:159], v179 offset:34816
s_waitcnt vmcnt(4) lgkmcnt(15)
v_mfma_f32_16x16x32_bf16 a[240:243], v[160:163], v[88:91], a[240:243]
ds_read_b64_tr_b16 v[160:161], v176 offset:36864
ds_read_b64_tr_b16 v[162:163], v176 offset:38912
v_mfma_f32_16x16x32_bf16 a[244:247], v[164:167], v[88:91], a[244:247]
ds_read_b64_tr_b16 v[164:165], v177 offset:36864
ds_read_b64_tr_b16 v[166:167], v177 offset:38912
v_mfma_f32_16x16x32_bf16 a[248:251], v[168:171], v[88:91], a[248:251]
ds_read_b64_tr_b16 v[168:169], v178 offset:36864
ds_read_b64_tr_b16 v[170:171], v178 offset:38912
v_mfma_f32_16x16x32_bf16 a[252:255], v[172:175], v[88:91], a[252:255]
ds_read_b64_tr_b16 v[172:173], v179 offset:36864
ds_read_b64_tr_b16 v[174:175], v179 offset:38912
s_waitcnt vmcnt(3)
v_mfma_f32_16x16x32_bf16 a[240:243], v[128:131], v[92:95], a[240:243]
ds_read_b64_tr_b16 v[128:129], v176 offset:40960
ds_read_b64_tr_b16 v[130:131], v176 offset:43008
v_mfma_f32_16x16x32_bf16 a[244:247], v[132:135], v[92:95], a[244:247]
ds_read_b64_tr_b16 v[132:133], v177 offset:40960
ds_read_b64_tr_b16 v[134:135], v177 offset:43008
v_mfma_f32_16x16x32_bf16 a[248:251], v[136:139], v[92:95], a[248:251]
ds_read_b64_tr_b16 v[136:137], v178 offset:40960
ds_read_b64_tr_b16 v[138:139], v178 offset:43008
v_mfma_f32_16x16x32_bf16 a[252:255], v[140:143], v[92:95], a[252:255]
ds_read_b64_tr_b16 v[140:141], v179 offset:40960
ds_read_b64_tr_b16 v[142:143], v179 offset:43008
s_waitcnt vmcnt(2) lgkmcnt(15)
v_mfma_f32_16x16x32_bf16 a[240:243], v[144:147], v[96:99], a[240:243]
v_mfma_f32_16x16x32_bf16 a[244:247], v[148:151], v[96:99], a[244:247]
v_mfma_f32_16x16x32_bf16 a[248:251], v[152:155], v[96:99], a[248:251]
v_mfma_f32_16x16x32_bf16 a[252:255], v[156:159], v[96:99], a[252:255]
s_waitcnt vmcnt(1)
v_mfma_f32_16x16x32_bf16 a[240:243], v[160:163], v[100:103], a[240:243]
v_mfma_f32_16x16x32_bf16 a[244:247], v[164:167], v[100:103], a[244:247]
v_mfma_f32_16x16x32_bf16 a[248:251], v[168:171], v[100:103], a[248:251]
v_mfma_f32_16x16x32_bf16 a[252:255], v[172:175], v[100:103], a[252:255]
s_waitcnt vmcnt(0) lgkmcnt(0)
v_mfma_f32_16x16x32_bf16 a[240:243], v[128:131], v[104:107], a[240:243]
v_mfma_f32_16x16x32_bf16 a[244:247], v[132:135], v[104:107], a[244:247]
v_mfma_f32_16x16x32_bf16 a[248:251], v[136:139], v[104:107], a[248:251]
v_mfma_f32_16x16x32_bf16 a[252:255], v[140:143], v[104:107], a[252:255]
s_nop 4
s_nop 0
v_accvgpr_read_b32 v40, a240
v_accvgpr_read_b32 v41, a241
v_accvgpr_read_b32 v42, a242
v_accvgpr_read_b32 v43, a243
v_accvgpr_read_b32 v44, a244
v_accvgpr_read_b32 v45, a245
v_accvgpr_read_b32 v46, a246
v_accvgpr_read_b32 v47, a247
v_accvgpr_read_b32 v48, a248
v_accvgpr_read_b32 v49, a249
v_accvgpr_read_b32 v50, a250
v_accvgpr_read_b32 v51, a251
v_accvgpr_read_b32 v52, a252
v_accvgpr_read_b32 v53, a253
v_accvgpr_read_b32 v54, a254
v_accvgpr_read_b32 v55, a255
v_cvt_pk_bf16_f32 v56, v40, v41
v_cvt_pk_bf16_f32 v57, v42, v43
v_cvt_pk_bf16_f32 v58, v44, v45
v_cvt_pk_bf16_f32 v59, v46, v47
v_cvt_pk_bf16_f32 v60, v48, v49
v_cvt_pk_bf16_f32 v61, v50, v51
v_cvt_pk_bf16_f32 v62, v52, v53
v_cvt_pk_bf16_f32 v63, v54, v55
v_permlane16_swap_b32 v56, v58
v_permlane16_swap_b32 v57, v59
v_permlane16_swap_b32 v60, v62
v_permlane16_swap_b32 v61, v63
buffer_store_dwordx4 v[56:59], v224, s[40:43], 0 offen offset:0
buffer_store_dwordx4 v[60:63], v224, s[40:43], 0 offen offset:64
s_waitcnt vmcnt(0)
s_nop 0
L_end:
s_endpgm

.section .rodata,"a"
.p2align 6
.amdhsa_kernel sequential_preLN__linear_kernel_hedgehog__mixer_s_mlp__prompt_kernel
  .amdhsa_next_free_vgpr 512
  .amdhsa_next_free_sgpr 102
  .amdhsa_accum_offset 256
  .amdhsa_group_segment_fixed_size 0
  .amdhsa_kernarg_size 96
  .amdhsa_user_sgpr_count 2
  .amdhsa_user_sgpr_kernarg_segment_ptr 1
  .amdhsa_system_sgpr_workgroup_id_x 1
  .amdhsa_float_denorm_mode_32 3
.end_amdhsa_kernel
```
